```python
import torch

def _softmax(x, axis=-1):
    return torch.softmax(x, dim=axis)
def _gelu(x):
    return torch.nn.functional.gelu(x, approximate="tanh")
def _silu(x):
    return torch.nn.functional.silu(x)
def _sigmoid(x):
    return torch.sigmoid(x)
def _layernorm(x, axis=-1, eps=1e-5):
    m = x.mean(dim=axis, keepdim=True)
    v = x.var(dim=axis, keepdim=True, unbiased=False)
    return (x - m) / torch.sqrt(v + eps)
def _scatter_add(tgt, idx, src, axis=0):
    return tgt.clone().index_add_(axis, idx, src)
def _segment_sum(src, seg, n):
    out = torch.zeros((n,) + src.shape[1:], dtype=src.dtype)
    return out.index_add_(0, seg, src)
def _pad(x, pw):
    flat = tuple(v for pair in reversed(pw) for v in pair)
    return torch.nn.functional.pad(x, flat)

kernel_name = 'concat_heads__mha_block_cached__sliding_block_cached__decode'

def setup_inputs():

    _w = (lambda a: (lambda t: t.to(torch.bfloat16) if t.is_floating_point() else t)(torch.as_tensor(a)))
    def _A_setup():
        B, Sq, D = 4, 1, 512
        H, Sk, Dh = 32, 4096, 128
        return {
            "x": _w((lambda *s: torch.randn(*s, dtype=torch.bfloat16) * 0.8)(B, Sq, D)),
            "k_cache": _w((lambda *s: torch.randn(*s, dtype=torch.bfloat16) * 1.6)(B, H, Sk, Dh)),
            "v_cache": _w((lambda *s: torch.randn(*s, dtype=torch.bfloat16) * 0.2)(B, H, Sk, Dh)),
            "wq": _w((lambda *s: torch.randn(*s, dtype=torch.bfloat16) * 1.6)(D, H * Dh) * (D ** -0.5)),
            "wo": _w((lambda *s: torch.randn(*s, dtype=torch.bfloat16) * 0.2)(H * Dh, D) * ((H * Dh) ** -0.5)),
        }
    _A_in = _A_setup()

    def _B_setup():
        B, Sq, D = 4, 1, 512
        Hq, Hkv, Sk, Dh = 32, 8, 4096, 128
        assert Hq % Hkv == 0, (Hq, Hkv)
        return {
            "x": _w((lambda *s: torch.randn(*s, dtype=torch.bfloat16) * 0.8)(B, Sq, D)),
            "k_cache": _w((lambda *s: torch.randn(*s, dtype=torch.bfloat16) * 1.6)(B, Hkv, Sk, Dh)),
            "v_cache": _w((lambda *s: torch.randn(*s, dtype=torch.bfloat16) * 0.2)(B, Hkv, Sk, Dh)),
            "wq": _w((lambda *s: torch.randn(*s, dtype=torch.bfloat16) * 1.6)(D, Hq * Dh) * (D ** -0.5)),
            "wo": _w((lambda *s: torch.randn(*s, dtype=torch.bfloat16) * 0.2)(Hq * Dh, D) * ((Hq * Dh) ** -0.5)),
        }
    _B_in = _B_setup()

    return {
        "A_x": _A_in["x"],
        "A_k_cache": _A_in["k_cache"],
        "A_v_cache": _A_in["v_cache"],
        "A_wq": _A_in["wq"],
        "A_wo": _A_in["wo"],
        "B_x": _B_in["x"],
        "B_k_cache": _B_in["k_cache"],
        "B_v_cache": _B_in["v_cache"],
        "B_wq": _B_in["wq"],
        "B_wo": _B_in["wo"],
    }

def reference(A_x, A_k_cache, A_v_cache, A_wq, A_wo, B_x, B_k_cache, B_v_cache, B_wq, B_wo):
    def _A_ref(x, k_cache, v_cache, wq, wo):
        B, Sq, D = x.shape
        H, Dh = 32, 128
        q = (lambda x, *d: x.permute(*d))((x @ wq).reshape(B, Sq, H, Dh), 0, 2, 1, 3)
        scores = torch.einsum("bhqd,bhkd->bhqk", q, k_cache) * (Dh ** -0.5)
        p = _softmax(scores, axis=-1)
        o = torch.einsum("bhqk,bhkd->bhqd", p, v_cache)
        return (lambda x, *d: x.permute(*d))(o, 0, 2, 1, 3).reshape(B, Sq, H * Dh) @ wo

    def _B_ref(x, k_cache, v_cache, wq, wo):
        B, Sq, D = x.shape
        Hq, Dh = 32, 128
        Hkv, Sk = k_cache.shape[1], k_cache.shape[2]
        W = min(4096, max(256, Sk // 4))
        rep = Hq // Hkv
        q = (lambda x, *d: x.permute(*d))((x @ wq).reshape(B, Sq, Hq, Dh), 0, 2, 1, 3)
        k = (lambda x, n, axis: torch.repeat_interleave(x, n, dim=axis))(k_cache[:, :, Sk - W:, :], rep, axis=1)
        v = (lambda x, n, axis: torch.repeat_interleave(x, n, dim=axis))(v_cache[:, :, Sk - W:, :], rep, axis=1)
        scores = torch.einsum("bhqd,bhkd->bhqk", q, k) * (Dh ** -0.5)
        p = _softmax(scores, axis=-1)
        o = torch.einsum("bhqk,bhkd->bhqd", p, v)
        return (lambda x, *d: x.permute(*d))(o, 0, 2, 1, 3).reshape(B, Sq, Hq * Dh) @ wo

    a = _A_ref(A_x, A_k_cache, A_v_cache, A_wq, A_wo)
    b = _B_ref(B_x, B_k_cache, B_v_cache, B_wq, B_wo)
    return torch.concatenate([a, b], axis=-1)
```

```asm
; @launch grid=(256,1,1) block=(1024,1,1) lds=97536
.amdgcn_target "amdgcn-amd-amdhsa--gfx950"
.text
.globl concat_heads__mha_block_cached__sliding_block_cached__decode_kernel
.p2align 8
.type concat_heads__mha_block_cached__sliding_block_cached__decode_kernel,@function
concat_heads__mha_block_cached__sliding_block_cached__decode_kernel:
    s_load_dwordx16 s[16:31], s[0:1], 0
    s_load_dwordx8 s[32:39], s[0:1], 64
    s_load_dwordx2 s[40:41], s[0:1], 96
    v_lshrrev_b32 v1, 6, v0
    s_cmp_ge_u32 s2, 256
    s_cbranch_scc1 L_end0
    v_readfirstlane_b32 s3, v1
    v_and_b32 v0, 63, v0
    s_and_b32 s5, s3, 7
    s_cmp_ge_u32 s3, 8
    s_cbranch_scc1 L_A
    s_setprio 3
    v_lshrrev_b32 v4, 3, v0
    v_lshl_add_u32 v4, v1, 5, v4
    v_lshlrev_b32 v4, 13, v4
    v_and_b32 v5, 7, v0
    v_lshl_add_u32 v4, v5, 4, v4
    s_lshr_b32 s69, s2, 1
    s_and_b32 s69, s69, 0x3c
    s_and_b32 s6, s2, 3
    s_or_b32 s69, s69, s6
    s_bitcmp1_b32 s2, 2
    s_cselect_b32 s6, 5, 7
    s_xor_b32 s69, s69, s6
    s_lshr_b32 s6, s2, 7
    s_lshl_b32 s7, s6, 21
    s_lshl_b32 s43, s69, 7
    s_add_u32 s7, s7, s43
    v_add_u32 v4, s7, v4
    v_add_u32 v5, 0x10000, v4
    v_add_u32 v8, 0x20000, v4
    v_add_u32 v9, 0x30000, v4
    v_and_b32 v6, 3, v0
    v_lshlrev_b32 v6, 10, v6
    v_lshl_add_u32 v6, v1, 6, v6
    v_and_b32 v1, 48, v0
    s_lshl_b32 s6, s6, 9
    v_add3_u32 v6, v6, v1, s6
    s_bitcmp1_b32 s2, 2
    s_waitcnt lgkmcnt(0)
    s_cselect_b64 s[22:23], s[32:33], s[22:23]
    s_cselect_b64 s[16:17], s[26:27], s[16:17]
    global_load_dwordx4 v[32:35], v4, s[22:23] nt
    global_load_dwordx4 v[36:39], v5, s[22:23] nt
    global_load_dwordx4 v[40:43], v8, s[22:23] nt
    global_load_dwordx4 v[44:47], v9, s[22:23] nt
    global_load_dwordx4 v[48:51], v6, s[16:17]
    s_load_dword s88, s[40:41], 0x18000
    s_barrier
    s_branch L_aux
L_end0:
    s_endpgm
L_A:
    s_setprio 2
    s_and_b32 s6, s2, 7
    s_lshl_b32 s6, s6, 1
    s_bfe_u32 s7, s2, 0x10003
    s_or_b32 s6, s6, s7
    s_andn2_b32 s2, s2, 15
    s_or_b32 s2, s2, s6
    s_and_b32 s4, s2, 0xc1
    s_bfe_u32 s6, s2, 0x10001
    s_lshl_b32 s6, s6, 1
    s_or_b32 s4, s4, s6
    s_bfe_u32 s6, s2, 0x10005
    s_lshl_b32 s6, s6, 2
    s_or_b32 s4, s4, s6
    s_bfe_u32 s6, s2, 0x10003
    s_lshl_b32 s6, s6, 3
    s_or_b32 s4, s4, s6
    s_bfe_u32 s6, s2, 0x10002
    s_lshl_b32 s6, s6, 4
    s_or_b32 s4, s4, s6
    s_bfe_u32 s6, s2, 0x10004
    s_lshl_b32 s6, s6, 5
    s_or_b32 s4, s4, s6
    v_lshlrev_b32 v2, 4, v0
    s_lshr_b32 s6, s4, 1
    s_lshl_b32 s6, s6, 20
    s_bitcmp1_b32 s2, 0
    s_cselect_b32 s50, 61, 0
    s_cselect_b32 s53, 67, 61
    s_add_u32 s52, s5, s50
    s_bfe_u32 s48, s52, 0x10000
    s_lshl_b32 s48, s48, 13
    s_bfe_u32 s7, s52, 0x10001
    s_lshl_b32 s7, s7, 12
    s_or_b32 s48, s48, s7
    s_bfe_u32 s7, s52, 0x10002
    s_lshl_b32 s7, s7, 14
    s_or_b32 s48, s48, s7
    s_bfe_u32 s7, s52, 0x20003
    s_lshl_b32 s7, s7, 18
    s_or_b32 s48, s48, s7
    s_bfe_u32 s7, s52, 0x10005
    s_lshl_b32 s7, s7, 17
    s_or_b32 s48, s48, s7
    s_bfe_u32 s7, s52, 0x10006
    s_lshl_b32 s7, s7, 16
    s_or_b32 s48, s48, s7
    v_mov_b32 v42, v2
    s_add_u32 s57, s48, 32768
    s_mov_b32 s10, 0x100000
    s_mov_b32 s11, 0x20000
    v_mov_b32 v30, 21504
    v_mov_b32 v60, 0
    v_mov_b32 v61, 0
    v_mov_b32 v62, 0x4000010
    v_mov_b32 v63, 0
    ds_write_b128 v30, v[60:63]
    s_lshl_b32 s7, s5, 10
    v_add_u32 v31, s7, v2
    v_mov_b32 v56, -1
    v_mov_b32 v57, -1
    v_mov_b32 v58, -1
    v_mov_b32 v59, -1
    ds_write_b128 v31, v[56:59] offset:8192
    ds_write_b128 v2, v[56:59] offset:16384
    s_waitcnt lgkmcnt(0)
    s_add_u32 s8, s18, s6
    s_addc_u32 s9, s19, 0
    s_barrier
    buffer_load_dwordx4 v[64:67], v42, s[8:11], s48 offen offset:0 nt
    buffer_load_dwordx4 v[68:71], v42, s[8:11], s48 offen offset:2048 nt
    buffer_load_dwordx4 v[72:75], v42, s[8:11], s48 offen offset:1024 nt
    buffer_load_dwordx4 v[76:79], v42, s[8:11], s48 offen offset:3072 nt
    s_add_u32 s12, s20, s6
    s_addc_u32 s13, s21, 0
    s_mov_b32 s30, s53
    s_add_u32 s52, s52, 8
    s_bfe_u32 s49, s52, 0x10000
    s_lshl_b32 s49, s49, 13
    s_bfe_u32 s7, s52, 0x10001
    s_lshl_b32 s7, s7, 12
    s_or_b32 s49, s49, s7
    s_bfe_u32 s7, s52, 0x10002
    s_lshl_b32 s7, s7, 14
    s_or_b32 s49, s49, s7
    s_bfe_u32 s7, s52, 0x20003
    s_lshl_b32 s7, s7, 18
    s_or_b32 s49, s49, s7
    s_bfe_u32 s7, s52, 0x10005
    s_lshl_b32 s7, s7, 17
    s_or_b32 s49, s49, s7
    s_bfe_u32 s7, s52, 0x10006
    s_lshl_b32 s7, s7, 16
    s_or_b32 s49, s49, s7
    s_add_u32 s59, s49, 32768
    s_waitcnt vmcnt(1)
    buffer_load_dwordx4 v[80:83], v42, s[8:11], s57 offen offset:0 nt
    buffer_load_dwordx4 v[84:87], v42, s[8:11], s57 offen offset:2048 nt
    buffer_load_dwordx4 v[88:91], v42, s[8:11], s57 offen offset:1024 nt
    buffer_load_dwordx4 v[92:95], v42, s[8:11], s57 offen offset:3072 nt
    s_waitcnt vmcnt(1)
    buffer_load_dwordx4 v[96:99], v42, s[8:11], s49 offen offset:0 nt
    buffer_load_dwordx4 v[100:103], v42, s[8:11], s49 offen offset:2048 nt
    buffer_load_dwordx4 v[104:107], v42, s[8:11], s49 offen offset:1024 nt
    buffer_load_dwordx4 v[108:111], v42, s[8:11], s49 offen offset:3072 nt
    s_waitcnt vmcnt(1)
    buffer_load_dwordx4 v[112:115], v42, s[8:11], s59 offen offset:0 nt
    buffer_load_dwordx4 v[116:119], v42, s[8:11], s59 offen offset:2048 nt
    buffer_load_dwordx4 v[120:123], v42, s[8:11], s59 offen offset:1024 nt
    buffer_load_dwordx4 v[124:127], v42, s[8:11], s59 offen offset:3072 nt
    s_mov_b32 s54, 0x3e0293ee
    s_mov_b32 s55, 0xbe0293ee
    s_mov_b32 s64, 0
    s_mov_b32 s65, 0
    s_lshl_b32 s66, s5, 7
    s_add_u32 s67, s66, 1024
    s_mov_b32 s18, 0x100000
    s_mov_b32 s19, 0x20000
    v_and_b32 v40, 48, v0
    s_mov_b32 s20, 0x00010001
    s_mov_b32 s21, 0x00010001
    s_lshl_b32 s51, s30, 1
    s_sub_u32 s51, s51, 8
    s_mov_b32 s62, 0
    s_lshl_b32 s29, s30, 1
    v_mov_b32 v44, 0
    v_and_b32 v43, 0xf0, v2
    v_mov_b32 v8, 0
    v_mov_b32 v9, 0
    v_mov_b32 v10, 0
    v_mov_b32 v11, 0
    v_mov_b32 v12, 0
    v_mov_b32 v13, 0
    v_mov_b32 v14, 0
    v_mov_b32 v15, 0
    v_mov_b32 v16, 0xff7fffff
    v_mov_b32 v17, 0
    s_mul_i32 s56, s5, 272
    s_add_u32 s56, s56, 17408
    s_lshl_b32 s58, s5, 3
    s_add_u32 s58, s58, 19584
    v_mov_b32 v46, 0x10000
    v_mov_b32 v45, 1
    v_mov_b32 v30, 21508
L_wq:
    ds_read_u16 v31, v30
    s_waitcnt lgkmcnt(0)
    v_readfirstlane_b32 s6, v31
    s_nop 0
    s_cmp_lg_u32 s6, 0
    s_cbranch_scc1 L_wq_ok
    s_sleep 1
    s_branch L_wq
L_wq_ok:
    ds_read_b128 v[4:7], v43 offset:20224
    ds_read_b32 v39, v30 offset:12
    s_waitcnt lgkmcnt(0)
L_loop:
    v_add_u32 v41, s66, v40
    s_cmp_eq_u32 s64, 1
    s_cbranch_scc1 L_V0
    s_cmp_eq_u32 s62, 0
    s_cbranch_scc1 L_kw0
    s_waitcnt vmcnt(0)
L_kw0:
    s_waitcnt vmcnt(8)
    v_dot2_f32_bf16 v18, v64, v4, 0
    v_dot2_f32_bf16 v19, v68, v4, 0
    v_dot2_f32_bf16 v20, v72, v4, 0
    v_dot2_f32_bf16 v21, v76, v4, 0
    v_dot2_f32_bf16 v22, v80, v4, 0
    v_dot2_f32_bf16 v23, v84, v4, 0
    v_dot2_f32_bf16 v24, v88, v4, 0
    v_dot2_f32_bf16 v25, v92, v4, 0
    v_dot2_f32_bf16 v18, v65, v5, v18
    v_dot2_f32_bf16 v19, v69, v5, v19
    v_dot2_f32_bf16 v20, v73, v5, v20
    v_dot2_f32_bf16 v21, v77, v5, v21
    v_dot2_f32_bf16 v22, v81, v5, v22
    v_dot2_f32_bf16 v23, v85, v5, v23
    v_dot2_f32_bf16 v24, v89, v5, v24
    v_dot2_f32_bf16 v25, v93, v5, v25
    v_dot2_f32_bf16 v18, v66, v6, v18
    v_dot2_f32_bf16 v19, v70, v6, v19
    v_dot2_f32_bf16 v20, v74, v6, v20
    v_dot2_f32_bf16 v21, v78, v6, v21
    v_dot2_f32_bf16 v22, v82, v6, v22
    v_dot2_f32_bf16 v23, v86, v6, v23
    v_dot2_f32_bf16 v24, v90, v6, v24
    v_dot2_f32_bf16 v25, v94, v6, v25
    v_dot2_f32_bf16 v18, v67, v7, v18
    v_dot2_f32_bf16 v19, v71, v7, v19
    v_dot2_f32_bf16 v20, v75, v7, v20
    v_dot2_f32_bf16 v21, v79, v7, v21
    v_dot2_f32_bf16 v22, v83, v7, v22
    v_dot2_f32_bf16 v23, v87, v7, v23
    v_dot2_f32_bf16 v24, v91, v7, v24
    v_dot2_f32_bf16 v25, v95, v7, v25
    s_mov_b64 exec, 1
    ds_add_rtn_u32 v3, v44, v45 offset:21512
    s_mov_b64 exec, -1
    v_add_f32_dpp v18, v18, v18 row_ror:8 row_mask:0xf bank_mask:0xf
    v_add_f32_dpp v19, v19, v19 row_ror:8 row_mask:0xf bank_mask:0xf
    v_add_f32_dpp v20, v20, v20 row_ror:8 row_mask:0xf bank_mask:0xf
    v_add_f32_dpp v21, v21, v21 row_ror:8 row_mask:0xf bank_mask:0xf
    v_add_f32_dpp v22, v22, v22 row_ror:8 row_mask:0xf bank_mask:0xf
    v_add_f32_dpp v23, v23, v23 row_ror:8 row_mask:0xf bank_mask:0xf
    v_add_f32_dpp v24, v24, v24 row_ror:8 row_mask:0xf bank_mask:0xf
    v_add_f32_dpp v25, v25, v25 row_ror:8 row_mask:0xf bank_mask:0xf
    v_add_f32_dpp v18, v18, v18 row_ror:4 row_mask:0xf bank_mask:0xf
    v_add_f32_dpp v19, v19, v19 row_ror:4 row_mask:0xf bank_mask:0xf
    v_add_f32_dpp v20, v20, v20 row_ror:4 row_mask:0xf bank_mask:0xf
    v_add_f32_dpp v21, v21, v21 row_ror:4 row_mask:0xf bank_mask:0xf
    v_add_f32_dpp v22, v22, v22 row_ror:4 row_mask:0xf bank_mask:0xf
    v_add_f32_dpp v23, v23, v23 row_ror:4 row_mask:0xf bank_mask:0xf
    v_add_f32_dpp v24, v24, v24 row_ror:4 row_mask:0xf bank_mask:0xf
    v_add_f32_dpp v25, v25, v25 row_ror:4 row_mask:0xf bank_mask:0xf
    v_add_f32_dpp v18, v18, v18 row_ror:2 row_mask:0xf bank_mask:0xf
    v_add_f32_dpp v19, v19, v19 row_ror:2 row_mask:0xf bank_mask:0xf
    v_add_f32_dpp v20, v20, v20 row_ror:2 row_mask:0xf bank_mask:0xf
    v_add_f32_dpp v21, v21, v21 row_ror:2 row_mask:0xf bank_mask:0xf
    v_add_f32_dpp v22, v22, v22 row_ror:2 row_mask:0xf bank_mask:0xf
    v_add_f32_dpp v23, v23, v23 row_ror:2 row_mask:0xf bank_mask:0xf
    v_add_f32_dpp v24, v24, v24 row_ror:2 row_mask:0xf bank_mask:0xf
    v_add_f32_dpp v25, v25, v25 row_ror:2 row_mask:0xf bank_mask:0xf
    v_add_f32_dpp v18, v18, v18 row_ror:1 row_mask:0xf bank_mask:0xf
    v_add_f32_dpp v19, v19, v19 row_ror:1 row_mask:0xf bank_mask:0xf
    v_add_f32_dpp v20, v20, v20 row_ror:1 row_mask:0xf bank_mask:0xf
    v_add_f32_dpp v21, v21, v21 row_ror:1 row_mask:0xf bank_mask:0xf
    v_add_f32_dpp v22, v22, v22 row_ror:1 row_mask:0xf bank_mask:0xf
    v_add_f32_dpp v23, v23, v23 row_ror:1 row_mask:0xf bank_mask:0xf
    v_add_f32_dpp v24, v24, v24 row_ror:1 row_mask:0xf bank_mask:0xf
    v_add_f32_dpp v25, v25, v25 row_ror:1 row_mask:0xf bank_mask:0xf
    s_mov_b64 exec, s[20:21]
    ds_write_b128 v41, v[18:21] offset:8192
    ds_write_b128 v41, v[22:25] offset:8256
    s_mov_b64 exec, -1
    s_cbranch_scc1 L_iss0
    s_waitcnt lgkmcnt(0)
    s_call_b64 s[90:91], L_epi
    s_branch L_done
L_V0:
    s_mov_b32 s22, 0x400000
L_Vr0:
    ds_read_b128 v[18:21], v41 offset:8192
    ds_read_b128 v[22:25], v41 offset:8256
    s_sub_u32 s22, s22, 1
    s_waitcnt lgkmcnt(0)
    v_max3_u32 v1, v18, v19, v20
    v_max3_u32 v34, v21, v22, v23
    v_max3_u32 v1, v1, v24, v25
    v_max_u32 v1, v1, v34
    v_cmp_eq_u32 vcc, -1, v1
    s_cbranch_scc1 L_Vg0
    s_cbranch_vccnz L_Vr0
L_Vg0:
    v_max3_f32 v34, v18, v19, v20
    v_max3_f32 v35, v21, v22, v23
    v_max3_f32 v34, v34, v24, v25
    v_max3_f32 v34, v34, v35, v16
    v_sub_f32 v35, v16, v34
    v_mul_f32 v1, s55, v34
    v_mul_f32 v35, s54, v35
    v_fma_f32 v18, v18, s54, v1
    v_fma_f32 v19, v19, s54, v1
    v_fma_f32 v20, v20, s54, v1
    v_fma_f32 v21, v21, s54, v1
    v_fma_f32 v22, v22, s54, v1
    v_fma_f32 v23, v23, s54, v1
    v_fma_f32 v24, v24, s54, v1
    v_fma_f32 v25, v25, s54, v1
    v_exp_f32 v35, v35
    v_exp_f32 v18, v18
    v_exp_f32 v19, v19
    v_exp_f32 v20, v20
    v_exp_f32 v21, v21
    v_exp_f32 v22, v22
    v_exp_f32 v23, v23
    v_exp_f32 v24, v24
    v_exp_f32 v25, v25
    v_mov_b32 v16, v34
    v_mul_f32 v8, v8, v35
    v_mul_f32 v9, v9, v35
    v_mul_f32 v10, v10, v35
    v_mul_f32 v11, v11, v35
    v_mul_f32 v12, v12, v35
    v_mul_f32 v13, v13, v35
    v_mul_f32 v14, v14, v35
    v_mul_f32 v15, v15, v35
    v_cvt_pk_bf16_f32 v26, v18, 0
    v_cvt_pk_bf16_f32 v27, v19, 0
    v_cvt_pk_bf16_f32 v28, v20, 0
    v_cvt_pk_bf16_f32 v29, v21, 0
    v_cvt_pk_bf16_f32 v30, v22, 0
    v_cvt_pk_bf16_f32 v31, v23, 0
    v_cvt_pk_bf16_f32 v32, v24, 0
    v_cvt_pk_bf16_f32 v33, v25, 0
    v_lshlrev_b32 v48, 16, v26
    v_lshlrev_b32 v49, 16, v27
    v_lshlrev_b32 v50, 16, v28
    v_lshlrev_b32 v51, 16, v29
    v_lshlrev_b32 v52, 16, v30
    v_lshlrev_b32 v53, 16, v31
    v_lshlrev_b32 v54, 16, v32
    v_lshlrev_b32 v55, 16, v33
    v_fma_f32 v17, v17, v35, v48
    v_add_f32 v34, v49, v50
    v_add_f32 v35, v51, v52
    v_add_f32 v1, v53, v54
    v_add_f32 v17, v17, v55
    v_add_f32 v34, v34, v35
    v_add_f32 v17, v17, v1
    v_add_f32 v17, v17, v34
    s_cmp_eq_u32 s62, 0
    s_cbranch_scc0 L_last0
    s_waitcnt vmcnt(8)
    v_dot2c_f32_bf16 v8, v64, v26
    v_dot2c_f32_bf16 v9, v64, v48
    v_dot2c_f32_bf16 v10, v65, v26
    v_dot2c_f32_bf16 v11, v65, v48
    v_dot2c_f32_bf16 v12, v66, v26
    v_dot2c_f32_bf16 v13, v66, v48
    v_dot2c_f32_bf16 v14, v67, v26
    v_dot2c_f32_bf16 v15, v67, v48
    v_dot2c_f32_bf16 v8, v68, v27
    v_dot2c_f32_bf16 v9, v68, v49
    v_dot2c_f32_bf16 v10, v69, v27
    v_dot2c_f32_bf16 v11, v69, v49
    v_dot2c_f32_bf16 v12, v70, v27
    v_dot2c_f32_bf16 v13, v70, v49
    v_dot2c_f32_bf16 v14, v71, v27
    v_dot2c_f32_bf16 v15, v71, v49
    v_dot2c_f32_bf16 v8, v72, v28
    v_dot2c_f32_bf16 v9, v72, v50
    v_dot2c_f32_bf16 v10, v73, v28
    v_dot2c_f32_bf16 v11, v73, v50
    v_dot2c_f32_bf16 v12, v74, v28
    v_dot2c_f32_bf16 v13, v74, v50
    v_dot2c_f32_bf16 v14, v75, v28
    v_dot2c_f32_bf16 v15, v75, v50
    v_dot2c_f32_bf16 v8, v76, v29
    v_dot2c_f32_bf16 v9, v76, v51
    v_dot2c_f32_bf16 v10, v77, v29
    v_dot2c_f32_bf16 v11, v77, v51
    v_dot2c_f32_bf16 v12, v78, v29
    v_dot2c_f32_bf16 v13, v78, v51
    v_dot2c_f32_bf16 v14, v79, v29
    v_dot2c_f32_bf16 v15, v79, v51
L_H20:
    s_mov_b64 exec, 1
    ds_add_rtn_u32 v3, v44, v45 offset:21512
    s_mov_b64 exec, -1
L_M20:
    v_dot2c_f32_bf16 v8, v80, v30
    v_dot2c_f32_bf16 v9, v80, v52
    v_dot2c_f32_bf16 v10, v81, v30
    v_dot2c_f32_bf16 v11, v81, v52
    v_dot2c_f32_bf16 v12, v82, v30
    v_dot2c_f32_bf16 v13, v82, v52
    v_dot2c_f32_bf16 v14, v83, v30
    v_dot2c_f32_bf16 v15, v83, v52
    v_dot2c_f32_bf16 v8, v84, v31
    v_dot2c_f32_bf16 v9, v84, v53
    v_dot2c_f32_bf16 v10, v85, v31
    v_dot2c_f32_bf16 v11, v85, v53
    v_dot2c_f32_bf16 v12, v86, v31
    v_dot2c_f32_bf16 v13, v86, v53
    v_dot2c_f32_bf16 v14, v87, v31
    v_dot2c_f32_bf16 v15, v87, v53
    v_dot2c_f32_bf16 v8, v88, v32
    v_dot2c_f32_bf16 v9, v88, v54
    v_dot2c_f32_bf16 v10, v89, v32
    v_dot2c_f32_bf16 v11, v89, v54
    v_dot2c_f32_bf16 v12, v90, v32
    v_dot2c_f32_bf16 v13, v90, v54
    v_dot2c_f32_bf16 v14, v91, v32
    v_dot2c_f32_bf16 v15, v91, v54
    v_dot2c_f32_bf16 v8, v92, v33
    v_dot2c_f32_bf16 v9, v92, v55
    v_dot2c_f32_bf16 v10, v93, v33
    v_dot2c_f32_bf16 v11, v93, v55
    v_dot2c_f32_bf16 v12, v94, v33
    v_dot2c_f32_bf16 v13, v94, v55
    v_dot2c_f32_bf16 v14, v95, v33
    v_dot2c_f32_bf16 v15, v95, v55
L_iss0:
    s_waitcnt lgkmcnt(0)
    v_readfirstlane_b32 s6, v3
    s_nop 0
    s_lshr_b32 s63, s6, 24
    s_and_b32 s6, s6, 0xffff
    s_cmp_ge_u32 s6, s29
    s_cbranch_scc1 L_pool0
    s_cmp_ge_u32 s6, s30
    s_cselect_b32 s64, 1, 0
    s_cselect_b32 s7, s30, 0
    s_cselect_b64 s[16:17], s[12:13], s[8:9]
    s_sub_u32 s7, s6, s7
    s_lshl_b32 s66, s7, 7
    s_add_u32 s22, s7, s50
    s_bfe_u32 s7, s22, 0x10000
    s_lshl_b32 s7, s7, 13
    s_bfe_u32 s23, s22, 0x10001
    s_lshl_b32 s23, s23, 12
    s_or_b32 s7, s7, s23
    s_bfe_u32 s23, s22, 0x10002
    s_lshl_b32 s23, s23, 14
    s_or_b32 s7, s7, s23
    s_bfe_u32 s23, s22, 0x20003
    s_lshl_b32 s23, s23, 18
    s_or_b32 s7, s7, s23
    s_bfe_u32 s23, s22, 0x10005
    s_lshl_b32 s23, s23, 17
    s_or_b32 s7, s7, s23
    s_bfe_u32 s23, s22, 0x10006
    s_lshl_b32 s23, s23, 16
    s_or_b32 s7, s7, s23
    s_add_u32 s23, s7, 32768
L_sel0:
    s_add_u32 s22, s6, 12
    s_cmp_ge_u32 s22, s29
    s_cbranch_scc1 L_gr0_0
    s_cmp_lt_u32 s5, s63
    s_cbranch_scc1 L_lo0
L_hi0:
    s_waitcnt vmcnt(2)
    buffer_load_dwordx4 v[64:67], v42, s[16:19], s7 offen offset:0 nt
    s_waitcnt vmcnt(2)
    buffer_load_dwordx4 v[68:71], v42, s[16:19], s7 offen offset:2048 nt
    s_waitcnt vmcnt(2)
    buffer_load_dwordx4 v[72:75], v42, s[16:19], s7 offen offset:1024 nt
    s_waitcnt vmcnt(2)
    buffer_load_dwordx4 v[76:79], v42, s[16:19], s7 offen offset:3072 nt
    s_waitcnt vmcnt(2)
    s_mov_b64 exec, 1
    ds_add_u32 v44, v46 offset:21512
    s_mov_b64 exec, -1
    buffer_load_dwordx4 v[80:83], v42, s[16:19], s23 offen offset:0 nt
    s_waitcnt vmcnt(2)
    buffer_load_dwordx4 v[84:87], v42, s[16:19], s23 offen offset:2048 nt
    s_waitcnt vmcnt(2)
    buffer_load_dwordx4 v[88:91], v42, s[16:19], s23 offen offset:1024 nt
    s_waitcnt vmcnt(2)
    buffer_load_dwordx4 v[92:95], v42, s[16:19], s23 offen offset:3072 nt
    s_branch L_nx0
L_w40:
    s_add_u32 s22, s5, 128
    s_cmp_lt_u32 s22, s63
    s_cbranch_scc0 L_hi0
L_w4b0:
    s_waitcnt vmcnt(3)
    buffer_load_dwordx4 v[64:67], v42, s[16:19], s7 offen offset:0 nt
    s_waitcnt vmcnt(3)
    buffer_load_dwordx4 v[68:71], v42, s[16:19], s7 offen offset:2048 nt
    s_waitcnt vmcnt(3)
    buffer_load_dwordx4 v[72:75], v42, s[16:19], s7 offen offset:1024 nt
    s_waitcnt vmcnt(3)
    buffer_load_dwordx4 v[76:79], v42, s[16:19], s7 offen offset:3072 nt
    s_waitcnt vmcnt(3)
    s_mov_b64 exec, 1
    ds_add_u32 v44, v46 offset:21512
    s_mov_b64 exec, -1
    buffer_load_dwordx4 v[80:83], v42, s[16:19], s23 offen offset:0 nt
    s_waitcnt vmcnt(3)
    buffer_load_dwordx4 v[84:87], v42, s[16:19], s23 offen offset:2048 nt
    s_waitcnt vmcnt(3)
    buffer_load_dwordx4 v[88:91], v42, s[16:19], s23 offen offset:1024 nt
    s_waitcnt vmcnt(3)
    buffer_load_dwordx4 v[92:95], v42, s[16:19], s23 offen offset:3072 nt
    s_branch L_nx0
L_lo0:
    s_cmp_ge_u32 s63, 128
    s_cbranch_scc1 L_w40
    s_waitcnt vmcnt(1)
    buffer_load_dwordx4 v[64:67], v42, s[16:19], s7 offen offset:0 nt
    s_waitcnt vmcnt(1)
    buffer_load_dwordx4 v[68:71], v42, s[16:19], s7 offen offset:2048 nt
    s_waitcnt vmcnt(1)
    buffer_load_dwordx4 v[72:75], v42, s[16:19], s7 offen offset:1024 nt
    s_waitcnt vmcnt(1)
    buffer_load_dwordx4 v[76:79], v42, s[16:19], s7 offen offset:3072 nt
    s_waitcnt vmcnt(1)
    s_mov_b64 exec, 1
    ds_add_u32 v44, v46 offset:21512
    s_mov_b64 exec, -1
    buffer_load_dwordx4 v[80:83], v42, s[16:19], s23 offen offset:0 nt
    s_waitcnt vmcnt(1)
    buffer_load_dwordx4 v[84:87], v42, s[16:19], s23 offen offset:2048 nt
    s_waitcnt vmcnt(1)
    buffer_load_dwordx4 v[88:91], v42, s[16:19], s23 offen offset:1024 nt
    s_waitcnt vmcnt(1)
    buffer_load_dwordx4 v[92:95], v42, s[16:19], s23 offen offset:3072 nt
    s_branch L_nx0
L_gr0_0:
    s_add_u32 s22, s6, 7
    s_cmp_ge_u32 s22, s29
    s_cbranch_scc1 L_gr0_1
L_gi0_0:
    s_waitcnt vmcnt(3)
    buffer_load_dwordx4 v[64:67], v42, s[16:19], s7 offen offset:0 nt
    s_waitcnt vmcnt(3)
    buffer_load_dwordx4 v[68:71], v42, s[16:19], s7 offen offset:2048 nt
    s_waitcnt vmcnt(3)
    buffer_load_dwordx4 v[72:75], v42, s[16:19], s7 offen offset:1024 nt
    s_waitcnt vmcnt(3)
    buffer_load_dwordx4 v[76:79], v42, s[16:19], s7 offen offset:3072 nt
    s_waitcnt vmcnt(3)
    s_mov_b64 exec, 1
    ds_add_u32 v44, v46 offset:21512
    s_mov_b64 exec, -1
    buffer_load_dwordx4 v[80:83], v42, s[16:19], s23 offen offset:0 nt
    s_waitcnt vmcnt(3)
    buffer_load_dwordx4 v[84:87], v42, s[16:19], s23 offen offset:2048 nt
    s_waitcnt vmcnt(3)
    buffer_load_dwordx4 v[88:91], v42, s[16:19], s23 offen offset:1024 nt
    s_waitcnt vmcnt(3)
    buffer_load_dwordx4 v[92:95], v42, s[16:19], s23 offen offset:3072 nt
    s_branch L_nx0
L_gr0_1:
    s_add_u32 s22, s6, 4
    s_cmp_ge_u32 s22, s29
    s_cbranch_scc1 L_gr0_2
L_gi0_1:
    s_waitcnt vmcnt(5)
    buffer_load_dwordx4 v[64:67], v42, s[16:19], s7 offen offset:0 nt
    s_waitcnt vmcnt(5)
    buffer_load_dwordx4 v[68:71], v42, s[16:19], s7 offen offset:2048 nt
    s_waitcnt vmcnt(5)
    buffer_load_dwordx4 v[72:75], v42, s[16:19], s7 offen offset:1024 nt
    s_waitcnt vmcnt(5)
    buffer_load_dwordx4 v[76:79], v42, s[16:19], s7 offen offset:3072 nt
    s_waitcnt vmcnt(5)
    s_mov_b64 exec, 1
    ds_add_u32 v44, v46 offset:21512
    s_mov_b64 exec, -1
    buffer_load_dwordx4 v[80:83], v42, s[16:19], s23 offen offset:0 nt
    s_waitcnt vmcnt(5)
    buffer_load_dwordx4 v[84:87], v42, s[16:19], s23 offen offset:2048 nt
    s_waitcnt vmcnt(5)
    buffer_load_dwordx4 v[88:91], v42, s[16:19], s23 offen offset:1024 nt
    s_waitcnt vmcnt(5)
    buffer_load_dwordx4 v[92:95], v42, s[16:19], s23 offen offset:3072 nt
    s_branch L_nx0
L_gr0_2:
L_gi0_2:
    s_waitcnt vmcnt(11)
    buffer_load_dwordx4 v[64:67], v42, s[16:19], s7 offen offset:0 nt
    s_waitcnt vmcnt(11)
    buffer_load_dwordx4 v[68:71], v42, s[16:19], s7 offen offset:2048 nt
    s_waitcnt vmcnt(11)
    buffer_load_dwordx4 v[72:75], v42, s[16:19], s7 offen offset:1024 nt
    s_waitcnt vmcnt(11)
    buffer_load_dwordx4 v[76:79], v42, s[16:19], s7 offen offset:3072 nt
    s_waitcnt vmcnt(11)
    s_mov_b64 exec, 1
    ds_add_u32 v44, v46 offset:21512
    s_mov_b64 exec, -1
    buffer_load_dwordx4 v[80:83], v42, s[16:19], s23 offen offset:0 nt
    s_waitcnt vmcnt(11)
    buffer_load_dwordx4 v[84:87], v42, s[16:19], s23 offen offset:2048 nt
    s_waitcnt vmcnt(11)
    buffer_load_dwordx4 v[88:91], v42, s[16:19], s23 offen offset:1024 nt
    s_waitcnt vmcnt(11)
    buffer_load_dwordx4 v[92:95], v42, s[16:19], s23 offen offset:3072 nt
    s_branch L_nx0
L_pool0:
    s_mov_b32 s62, 1
L_sw0:
L_nx0:
    v_add_u32 v41, s67, v40
    s_cmp_eq_u32 s65, 1
    s_cbranch_scc1 L_V1
    s_cmp_eq_u32 s62, 0
    s_cbranch_scc1 L_kw1
    s_waitcnt vmcnt(0)
L_kw1:
    s_waitcnt vmcnt(8)
    v_dot2_f32_bf16 v18, v96, v4, 0
    v_dot2_f32_bf16 v19, v100, v4, 0
    v_dot2_f32_bf16 v20, v104, v4, 0
    v_dot2_f32_bf16 v21, v108, v4, 0
    v_dot2_f32_bf16 v22, v112, v4, 0
    v_dot2_f32_bf16 v23, v116, v4, 0
    v_dot2_f32_bf16 v24, v120, v4, 0
    v_dot2_f32_bf16 v25, v124, v4, 0
    v_dot2_f32_bf16 v18, v97, v5, v18
    v_dot2_f32_bf16 v19, v101, v5, v19
    v_dot2_f32_bf16 v20, v105, v5, v20
    v_dot2_f32_bf16 v21, v109, v5, v21
    v_dot2_f32_bf16 v22, v113, v5, v22
    v_dot2_f32_bf16 v23, v117, v5, v23
    v_dot2_f32_bf16 v24, v121, v5, v24
    v_dot2_f32_bf16 v25, v125, v5, v25
    v_dot2_f32_bf16 v18, v98, v6, v18
    v_dot2_f32_bf16 v19, v102, v6, v19
    v_dot2_f32_bf16 v20, v106, v6, v20
    v_dot2_f32_bf16 v21, v110, v6, v21
    v_dot2_f32_bf16 v22, v114, v6, v22
    v_dot2_f32_bf16 v23, v118, v6, v23
    v_dot2_f32_bf16 v24, v122, v6, v24
    v_dot2_f32_bf16 v25, v126, v6, v25
    v_dot2_f32_bf16 v18, v99, v7, v18
    v_dot2_f32_bf16 v19, v103, v7, v19
    v_dot2_f32_bf16 v20, v107, v7, v20
    v_dot2_f32_bf16 v21, v111, v7, v21
    v_dot2_f32_bf16 v22, v115, v7, v22
    v_dot2_f32_bf16 v23, v119, v7, v23
    v_dot2_f32_bf16 v24, v123, v7, v24
    v_dot2_f32_bf16 v25, v127, v7, v25
    s_mov_b64 exec, 1
    ds_add_rtn_u32 v3, v44, v45 offset:21512
    s_mov_b64 exec, -1
    v_add_f32_dpp v18, v18, v18 row_ror:8 row_mask:0xf bank_mask:0xf
    v_add_f32_dpp v19, v19, v19 row_ror:8 row_mask:0xf bank_mask:0xf
    v_add_f32_dpp v20, v20, v20 row_ror:8 row_mask:0xf bank_mask:0xf
    v_add_f32_dpp v21, v21, v21 row_ror:8 row_mask:0xf bank_mask:0xf
    v_add_f32_dpp v22, v22, v22 row_ror:8 row_mask:0xf bank_mask:0xf
    v_add_f32_dpp v23, v23, v23 row_ror:8 row_mask:0xf bank_mask:0xf
    v_add_f32_dpp v24, v24, v24 row_ror:8 row_mask:0xf bank_mask:0xf
    v_add_f32_dpp v25, v25, v25 row_ror:8 row_mask:0xf bank_mask:0xf
    v_add_f32_dpp v18, v18, v18 row_ror:4 row_mask:0xf bank_mask:0xf
    v_add_f32_dpp v19, v19, v19 row_ror:4 row_mask:0xf bank_mask:0xf
    v_add_f32_dpp v20, v20, v20 row_ror:4 row_mask:0xf bank_mask:0xf
    v_add_f32_dpp v21, v21, v21 row_ror:4 row_mask:0xf bank_mask:0xf
    v_add_f32_dpp v22, v22, v22 row_ror:4 row_mask:0xf bank_mask:0xf
    v_add_f32_dpp v23, v23, v23 row_ror:4 row_mask:0xf bank_mask:0xf
    v_add_f32_dpp v24, v24, v24 row_ror:4 row_mask:0xf bank_mask:0xf
    v_add_f32_dpp v25, v25, v25 row_ror:4 row_mask:0xf bank_mask:0xf
    v_add_f32_dpp v18, v18, v18 row_ror:2 row_mask:0xf bank_mask:0xf
    v_add_f32_dpp v19, v19, v19 row_ror:2 row_mask:0xf bank_mask:0xf
    v_add_f32_dpp v20, v20, v20 row_ror:2 row_mask:0xf bank_mask:0xf
    v_add_f32_dpp v21, v21, v21 row_ror:2 row_mask:0xf bank_mask:0xf
    v_add_f32_dpp v22, v22, v22 row_ror:2 row_mask:0xf bank_mask:0xf
    v_add_f32_dpp v23, v23, v23 row_ror:2 row_mask:0xf bank_mask:0xf
    v_add_f32_dpp v24, v24, v24 row_ror:2 row_mask:0xf bank_mask:0xf
    v_add_f32_dpp v25, v25, v25 row_ror:2 row_mask:0xf bank_mask:0xf
    v_add_f32_dpp v18, v18, v18 row_ror:1 row_mask:0xf bank_mask:0xf
    v_add_f32_dpp v19, v19, v19 row_ror:1 row_mask:0xf bank_mask:0xf
    v_add_f32_dpp v20, v20, v20 row_ror:1 row_mask:0xf bank_mask:0xf
    v_add_f32_dpp v21, v21, v21 row_ror:1 row_mask:0xf bank_mask:0xf
    v_add_f32_dpp v22, v22, v22 row_ror:1 row_mask:0xf bank_mask:0xf
    v_add_f32_dpp v23, v23, v23 row_ror:1 row_mask:0xf bank_mask:0xf
    v_add_f32_dpp v24, v24, v24 row_ror:1 row_mask:0xf bank_mask:0xf
    v_add_f32_dpp v25, v25, v25 row_ror:1 row_mask:0xf bank_mask:0xf
    s_mov_b64 exec, s[20:21]
    ds_write_b128 v41, v[18:21] offset:8192
    ds_write_b128 v41, v[22:25] offset:8256
    s_mov_b64 exec, -1
    s_cbranch_scc1 L_iss1
    s_waitcnt lgkmcnt(0)
    s_call_b64 s[90:91], L_epi
    s_branch L_done
L_V1:
    s_mov_b32 s22, 0x400000
L_Vr1:
    ds_read_b128 v[18:21], v41 offset:8192
    ds_read_b128 v[22:25], v41 offset:8256
    s_sub_u32 s22, s22, 1
    s_waitcnt lgkmcnt(0)
    v_max3_u32 v1, v18, v19, v20
    v_max3_u32 v34, v21, v22, v23
    v_max3_u32 v1, v1, v24, v25
    v_max_u32 v1, v1, v34
    v_cmp_eq_u32 vcc, -1, v1
    s_cbranch_scc1 L_Vg1
    s_cbranch_vccnz L_Vr1
L_Vg1:
    v_max3_f32 v34, v18, v19, v20
    v_max3_f32 v35, v21, v22, v23
    v_max3_f32 v34, v34, v24, v25
    v_max3_f32 v34, v34, v35, v16
    v_sub_f32 v35, v16, v34
    v_mul_f32 v1, s55, v34
    v_mul_f32 v35, s54, v35
    v_fma_f32 v18, v18, s54, v1
    v_fma_f32 v19, v19, s54, v1
    v_fma_f32 v20, v20, s54, v1
    v_fma_f32 v21, v21, s54, v1
    v_fma_f32 v22, v22, s54, v1
    v_fma_f32 v23, v23, s54, v1
    v_fma_f32 v24, v24, s54, v1
    v_fma_f32 v25, v25, s54, v1
    v_exp_f32 v35, v35
    v_exp_f32 v18, v18
    v_exp_f32 v19, v19
    v_exp_f32 v20, v20
    v_exp_f32 v21, v21
    v_exp_f32 v22, v22
    v_exp_f32 v23, v23
    v_exp_f32 v24, v24
    v_exp_f32 v25, v25
    v_mov_b32 v16, v34
    v_mul_f32 v8, v8, v35
    v_mul_f32 v9, v9, v35
    v_mul_f32 v10, v10, v35
    v_mul_f32 v11, v11, v35
    v_mul_f32 v12, v12, v35
    v_mul_f32 v13, v13, v35
    v_mul_f32 v14, v14, v35
    v_mul_f32 v15, v15, v35
    v_cvt_pk_bf16_f32 v26, v18, 0
    v_cvt_pk_bf16_f32 v27, v19, 0
    v_cvt_pk_bf16_f32 v28, v20, 0
    v_cvt_pk_bf16_f32 v29, v21, 0
    v_cvt_pk_bf16_f32 v30, v22, 0
    v_cvt_pk_bf16_f32 v31, v23, 0
    v_cvt_pk_bf16_f32 v32, v24, 0
    v_cvt_pk_bf16_f32 v33, v25, 0
    v_lshlrev_b32 v48, 16, v26
    v_lshlrev_b32 v49, 16, v27
    v_lshlrev_b32 v50, 16, v28
    v_lshlrev_b32 v51, 16, v29
    v_lshlrev_b32 v52, 16, v30
    v_lshlrev_b32 v53, 16, v31
    v_lshlrev_b32 v54, 16, v32
    v_lshlrev_b32 v55, 16, v33
    v_fma_f32 v17, v17, v35, v48
    v_add_f32 v34, v49, v50
    v_add_f32 v35, v51, v52
    v_add_f32 v1, v53, v54
    v_add_f32 v17, v17, v55
    v_add_f32 v34, v34, v35
    v_add_f32 v17, v17, v1
    v_add_f32 v17, v17, v34
    s_cmp_eq_u32 s62, 0
    s_cbranch_scc0 L_last1
    s_waitcnt vmcnt(8)
    v_dot2c_f32_bf16 v8, v96, v26
    v_dot2c_f32_bf16 v9, v96, v48
    v_dot2c_f32_bf16 v10, v97, v26
    v_dot2c_f32_bf16 v11, v97, v48
    v_dot2c_f32_bf16 v12, v98, v26
    v_dot2c_f32_bf16 v13, v98, v48
    v_dot2c_f32_bf16 v14, v99, v26
    v_dot2c_f32_bf16 v15, v99, v48
    v_dot2c_f32_bf16 v8, v100, v27
    v_dot2c_f32_bf16 v9, v100, v49
    v_dot2c_f32_bf16 v10, v101, v27
    v_dot2c_f32_bf16 v11, v101, v49
    v_dot2c_f32_bf16 v12, v102, v27
    v_dot2c_f32_bf16 v13, v102, v49
    v_dot2c_f32_bf16 v14, v103, v27
    v_dot2c_f32_bf16 v15, v103, v49
    v_dot2c_f32_bf16 v8, v104, v28
    v_dot2c_f32_bf16 v9, v104, v50
    v_dot2c_f32_bf16 v10, v105, v28
    v_dot2c_f32_bf16 v11, v105, v50
    v_dot2c_f32_bf16 v12, v106, v28
    v_dot2c_f32_bf16 v13, v106, v50
    v_dot2c_f32_bf16 v14, v107, v28
    v_dot2c_f32_bf16 v15, v107, v50
    v_dot2c_f32_bf16 v8, v108, v29
    v_dot2c_f32_bf16 v9, v108, v51
    v_dot2c_f32_bf16 v10, v109, v29
    v_dot2c_f32_bf16 v11, v109, v51
    v_dot2c_f32_bf16 v12, v110, v29
    v_dot2c_f32_bf16 v13, v110, v51
    v_dot2c_f32_bf16 v14, v111, v29
    v_dot2c_f32_bf16 v15, v111, v51
L_H21:
    s_mov_b64 exec, 1
    ds_add_rtn_u32 v3, v44, v45 offset:21512
    s_mov_b64 exec, -1
L_M21:
    v_dot2c_f32_bf16 v8, v112, v30
    v_dot2c_f32_bf16 v9, v112, v52
    v_dot2c_f32_bf16 v10, v113, v30
    v_dot2c_f32_bf16 v11, v113, v52
    v_dot2c_f32_bf16 v12, v114, v30
    v_dot2c_f32_bf16 v13, v114, v52
    v_dot2c_f32_bf16 v14, v115, v30
    v_dot2c_f32_bf16 v15, v115, v52
    v_dot2c_f32_bf16 v8, v116, v31
    v_dot2c_f32_bf16 v9, v116, v53
    v_dot2c_f32_bf16 v10, v117, v31
    v_dot2c_f32_bf16 v11, v117, v53
    v_dot2c_f32_bf16 v12, v118, v31
    v_dot2c_f32_bf16 v13, v118, v53
    v_dot2c_f32_bf16 v14, v119, v31
    v_dot2c_f32_bf16 v15, v119, v53
    v_dot2c_f32_bf16 v8, v120, v32
    v_dot2c_f32_bf16 v9, v120, v54
    v_dot2c_f32_bf16 v10, v121, v32
    v_dot2c_f32_bf16 v11, v121, v54
    v_dot2c_f32_bf16 v12, v122, v32
    v_dot2c_f32_bf16 v13, v122, v54
    v_dot2c_f32_bf16 v14, v123, v32
    v_dot2c_f32_bf16 v15, v123, v54
    v_dot2c_f32_bf16 v8, v124, v33
    v_dot2c_f32_bf16 v9, v124, v55
    v_dot2c_f32_bf16 v10, v125, v33
    v_dot2c_f32_bf16 v11, v125, v55
    v_dot2c_f32_bf16 v12, v126, v33
    v_dot2c_f32_bf16 v13, v126, v55
    v_dot2c_f32_bf16 v14, v127, v33
    v_dot2c_f32_bf16 v15, v127, v55
L_iss1:
    s_waitcnt lgkmcnt(0)
    v_readfirstlane_b32 s6, v3
    s_nop 0
    s_lshr_b32 s63, s6, 24
    s_and_b32 s6, s6, 0xffff
    s_cmp_ge_u32 s6, s29
    s_cbranch_scc1 L_pool1
    s_cmp_ge_u32 s6, s30
    s_cselect_b32 s65, 1, 0
    s_cselect_b32 s7, s30, 0
    s_cselect_b64 s[16:17], s[12:13], s[8:9]
    s_sub_u32 s7, s6, s7
    s_lshl_b32 s67, s7, 7
    s_add_u32 s22, s7, s50
    s_bfe_u32 s7, s22, 0x10000
    s_lshl_b32 s7, s7, 13
    s_bfe_u32 s23, s22, 0x10001
    s_lshl_b32 s23, s23, 12
    s_or_b32 s7, s7, s23
    s_bfe_u32 s23, s22, 0x10002
    s_lshl_b32 s23, s23, 14
    s_or_b32 s7, s7, s23
    s_bfe_u32 s23, s22, 0x20003
    s_lshl_b32 s23, s23, 18
    s_or_b32 s7, s7, s23
    s_bfe_u32 s23, s22, 0x10005
    s_lshl_b32 s23, s23, 17
    s_or_b32 s7, s7, s23
    s_bfe_u32 s23, s22, 0x10006
    s_lshl_b32 s23, s23, 16
    s_or_b32 s7, s7, s23
    s_add_u32 s23, s7, 32768
L_sel1:
    s_add_u32 s22, s6, 12
    s_cmp_ge_u32 s22, s29
    s_cbranch_scc1 L_gr1_0
    s_cmp_lt_u32 s5, s63
    s_cbranch_scc1 L_lo1
L_hi1:
    s_waitcnt vmcnt(2)
    buffer_load_dwordx4 v[96:99], v42, s[16:19], s7 offen offset:0 nt
    s_waitcnt vmcnt(2)
    buffer_load_dwordx4 v[100:103], v42, s[16:19], s7 offen offset:2048 nt
    s_waitcnt vmcnt(2)
    buffer_load_dwordx4 v[104:107], v42, s[16:19], s7 offen offset:1024 nt
    s_waitcnt vmcnt(2)
    buffer_load_dwordx4 v[108:111], v42, s[16:19], s7 offen offset:3072 nt
    s_waitcnt vmcnt(2)
    s_mov_b64 exec, 1
    ds_add_u32 v44, v46 offset:21512
    s_mov_b64 exec, -1
    buffer_load_dwordx4 v[112:115], v42, s[16:19], s23 offen offset:0 nt
    s_waitcnt vmcnt(2)
    buffer_load_dwordx4 v[116:119], v42, s[16:19], s23 offen offset:2048 nt
    s_waitcnt vmcnt(2)
    buffer_load_dwordx4 v[120:123], v42, s[16:19], s23 offen offset:1024 nt
    s_waitcnt vmcnt(2)
    buffer_load_dwordx4 v[124:127], v42, s[16:19], s23 offen offset:3072 nt
    s_branch L_nx1
L_w41:
    s_add_u32 s22, s5, 128
    s_cmp_lt_u32 s22, s63
    s_cbranch_scc0 L_hi1
L_w4b1:
    s_waitcnt vmcnt(3)
    buffer_load_dwordx4 v[96:99], v42, s[16:19], s7 offen offset:0 nt
    s_waitcnt vmcnt(3)
    buffer_load_dwordx4 v[100:103], v42, s[16:19], s7 offen offset:2048 nt
    s_waitcnt vmcnt(3)
    buffer_load_dwordx4 v[104:107], v42, s[16:19], s7 offen offset:1024 nt
    s_waitcnt vmcnt(3)
    buffer_load_dwordx4 v[108:111], v42, s[16:19], s7 offen offset:3072 nt
    s_waitcnt vmcnt(3)
    s_mov_b64 exec, 1
    ds_add_u32 v44, v46 offset:21512
    s_mov_b64 exec, -1
    buffer_load_dwordx4 v[112:115], v42, s[16:19], s23 offen offset:0 nt
    s_waitcnt vmcnt(3)
    buffer_load_dwordx4 v[116:119], v42, s[16:19], s23 offen offset:2048 nt
    s_waitcnt vmcnt(3)
    buffer_load_dwordx4 v[120:123], v42, s[16:19], s23 offen offset:1024 nt
    s_waitcnt vmcnt(3)
    buffer_load_dwordx4 v[124:127], v42, s[16:19], s23 offen offset:3072 nt
    s_branch L_nx1
L_lo1:
    s_cmp_ge_u32 s63, 128
    s_cbranch_scc1 L_w41
    s_waitcnt vmcnt(1)
    buffer_load_dwordx4 v[96:99], v42, s[16:19], s7 offen offset:0 nt
    s_waitcnt vmcnt(1)
    buffer_load_dwordx4 v[100:103], v42, s[16:19], s7 offen offset:2048 nt
    s_waitcnt vmcnt(1)
    buffer_load_dwordx4 v[104:107], v42, s[16:19], s7 offen offset:1024 nt
    s_waitcnt vmcnt(1)
    buffer_load_dwordx4 v[108:111], v42, s[16:19], s7 offen offset:3072 nt
    s_waitcnt vmcnt(1)
    s_mov_b64 exec, 1
    ds_add_u32 v44, v46 offset:21512
    s_mov_b64 exec, -1
    buffer_load_dwordx4 v[112:115], v42, s[16:19], s23 offen offset:0 nt
    s_waitcnt vmcnt(1)
    buffer_load_dwordx4 v[116:119], v42, s[16:19], s23 offen offset:2048 nt
    s_waitcnt vmcnt(1)
    buffer_load_dwordx4 v[120:123], v42, s[16:19], s23 offen offset:1024 nt
    s_waitcnt vmcnt(1)
    buffer_load_dwordx4 v[124:127], v42, s[16:19], s23 offen offset:3072 nt
    s_branch L_nx1
L_gr1_0:
    s_add_u32 s22, s6, 7
    s_cmp_ge_u32 s22, s29
    s_cbranch_scc1 L_gr1_1
L_gi1_0:
    s_waitcnt vmcnt(3)
    buffer_load_dwordx4 v[96:99], v42, s[16:19], s7 offen offset:0 nt
    s_waitcnt vmcnt(3)
    buffer_load_dwordx4 v[100:103], v42, s[16:19], s7 offen offset:2048 nt
    s_waitcnt vmcnt(3)
    buffer_load_dwordx4 v[104:107], v42, s[16:19], s7 offen offset:1024 nt
    s_waitcnt vmcnt(3)
    buffer_load_dwordx4 v[108:111], v42, s[16:19], s7 offen offset:3072 nt
    s_waitcnt vmcnt(3)
    s_mov_b64 exec, 1
    ds_add_u32 v44, v46 offset:21512
    s_mov_b64 exec, -1
    buffer_load_dwordx4 v[112:115], v42, s[16:19], s23 offen offset:0 nt
    s_waitcnt vmcnt(3)
    buffer_load_dwordx4 v[116:119], v42, s[16:19], s23 offen offset:2048 nt
    s_waitcnt vmcnt(3)
    buffer_load_dwordx4 v[120:123], v42, s[16:19], s23 offen offset:1024 nt
    s_waitcnt vmcnt(3)
    buffer_load_dwordx4 v[124:127], v42, s[16:19], s23 offen offset:3072 nt
    s_branch L_nx1
L_gr1_1:
    s_add_u32 s22, s6, 4
    s_cmp_ge_u32 s22, s29
    s_cbranch_scc1 L_gr1_2
L_gi1_1:
    s_waitcnt vmcnt(5)
    buffer_load_dwordx4 v[96:99], v42, s[16:19], s7 offen offset:0 nt
    s_waitcnt vmcnt(5)
    buffer_load_dwordx4 v[100:103], v42, s[16:19], s7 offen offset:2048 nt
    s_waitcnt vmcnt(5)
    buffer_load_dwordx4 v[104:107], v42, s[16:19], s7 offen offset:1024 nt
    s_waitcnt vmcnt(5)
    buffer_load_dwordx4 v[108:111], v42, s[16:19], s7 offen offset:3072 nt
    s_waitcnt vmcnt(5)
    s_mov_b64 exec, 1
    ds_add_u32 v44, v46 offset:21512
    s_mov_b64 exec, -1
    buffer_load_dwordx4 v[112:115], v42, s[16:19], s23 offen offset:0 nt
    s_waitcnt vmcnt(5)
    buffer_load_dwordx4 v[116:119], v42, s[16:19], s23 offen offset:2048 nt
    s_waitcnt vmcnt(5)
    buffer_load_dwordx4 v[120:123], v42, s[16:19], s23 offen offset:1024 nt
    s_waitcnt vmcnt(5)
    buffer_load_dwordx4 v[124:127], v42, s[16:19], s23 offen offset:3072 nt
    s_branch L_nx1
L_gr1_2:
L_gi1_2:
    s_waitcnt vmcnt(11)
    buffer_load_dwordx4 v[96:99], v42, s[16:19], s7 offen offset:0 nt
    s_waitcnt vmcnt(11)
    buffer_load_dwordx4 v[100:103], v42, s[16:19], s7 offen offset:2048 nt
    s_waitcnt vmcnt(11)
    buffer_load_dwordx4 v[104:107], v42, s[16:19], s7 offen offset:1024 nt
    s_waitcnt vmcnt(11)
    buffer_load_dwordx4 v[108:111], v42, s[16:19], s7 offen offset:3072 nt
    s_waitcnt vmcnt(11)
    s_mov_b64 exec, 1
    ds_add_u32 v44, v46 offset:21512
    s_mov_b64 exec, -1
    buffer_load_dwordx4 v[112:115], v42, s[16:19], s23 offen offset:0 nt
    s_waitcnt vmcnt(11)
    buffer_load_dwordx4 v[116:119], v42, s[16:19], s23 offen offset:2048 nt
    s_waitcnt vmcnt(11)
    buffer_load_dwordx4 v[120:123], v42, s[16:19], s23 offen offset:1024 nt
    s_waitcnt vmcnt(11)
    buffer_load_dwordx4 v[124:127], v42, s[16:19], s23 offen offset:3072 nt
    s_branch L_nx1
L_pool1:
    s_mov_b32 s62, 1
L_sw1:
L_nx1:
    s_branch L_loop
L_last0:
    s_call_b64 s[90:91], L_epi
    s_waitcnt vmcnt(7)
    v_dot2c_f32_bf16 v8, v64, v26
    v_dot2c_f32_bf16 v9, v64, v48
    v_dot2c_f32_bf16 v10, v65, v26
    v_dot2c_f32_bf16 v11, v65, v48
    v_dot2c_f32_bf16 v12, v66, v26
    v_dot2c_f32_bf16 v13, v66, v48
    v_dot2c_f32_bf16 v14, v67, v26
    v_dot2c_f32_bf16 v15, v67, v48
    s_waitcnt vmcnt(6)
    v_dot2c_f32_bf16 v8, v68, v27
    v_dot2c_f32_bf16 v9, v68, v49
    v_dot2c_f32_bf16 v10, v69, v27
    v_dot2c_f32_bf16 v11, v69, v49
    v_dot2c_f32_bf16 v12, v70, v27
    v_dot2c_f32_bf16 v13, v70, v49
    v_dot2c_f32_bf16 v14, v71, v27
    v_dot2c_f32_bf16 v15, v71, v49
    s_waitcnt vmcnt(5)
    v_dot2c_f32_bf16 v8, v72, v28
    v_dot2c_f32_bf16 v9, v72, v50
    v_dot2c_f32_bf16 v10, v73, v28
    v_dot2c_f32_bf16 v11, v73, v50
    v_dot2c_f32_bf16 v12, v74, v28
    v_dot2c_f32_bf16 v13, v74, v50
    v_dot2c_f32_bf16 v14, v75, v28
    v_dot2c_f32_bf16 v15, v75, v50
    s_waitcnt vmcnt(4)
    v_dot2c_f32_bf16 v8, v76, v29
    v_dot2c_f32_bf16 v9, v76, v51
    v_dot2c_f32_bf16 v10, v77, v29
    v_dot2c_f32_bf16 v11, v77, v51
    v_dot2c_f32_bf16 v12, v78, v29
    v_dot2c_f32_bf16 v13, v78, v51
    v_dot2c_f32_bf16 v14, v79, v29
    v_dot2c_f32_bf16 v15, v79, v51
L_l40:
    s_waitcnt vmcnt(3)
    v_dot2c_f32_bf16 v8, v80, v30
    v_dot2c_f32_bf16 v9, v80, v52
    v_dot2c_f32_bf16 v10, v81, v30
    v_dot2c_f32_bf16 v11, v81, v52
    v_dot2c_f32_bf16 v12, v82, v30
    v_dot2c_f32_bf16 v13, v82, v52
    v_dot2c_f32_bf16 v14, v83, v30
    v_dot2c_f32_bf16 v15, v83, v52
    s_waitcnt vmcnt(2)
    v_dot2c_f32_bf16 v8, v84, v31
    v_dot2c_f32_bf16 v9, v84, v53
    v_dot2c_f32_bf16 v10, v85, v31
    v_dot2c_f32_bf16 v11, v85, v53
    v_dot2c_f32_bf16 v12, v86, v31
    v_dot2c_f32_bf16 v13, v86, v53
    v_dot2c_f32_bf16 v14, v87, v31
    v_dot2c_f32_bf16 v15, v87, v53
    s_waitcnt vmcnt(1)
    v_dot2c_f32_bf16 v8, v88, v32
    v_dot2c_f32_bf16 v9, v88, v54
    v_dot2c_f32_bf16 v10, v89, v32
    v_dot2c_f32_bf16 v11, v89, v54
    v_dot2c_f32_bf16 v12, v90, v32
    v_dot2c_f32_bf16 v13, v90, v54
    v_dot2c_f32_bf16 v14, v91, v32
    v_dot2c_f32_bf16 v15, v91, v54
    s_waitcnt vmcnt(0)
    v_dot2c_f32_bf16 v8, v92, v33
    v_dot2c_f32_bf16 v9, v92, v55
    v_dot2c_f32_bf16 v10, v93, v33
    v_dot2c_f32_bf16 v11, v93, v55
    v_dot2c_f32_bf16 v12, v94, v33
    v_dot2c_f32_bf16 v13, v94, v55
    v_dot2c_f32_bf16 v14, v95, v33
    v_dot2c_f32_bf16 v15, v95, v55
    s_branch L_done
L_last1:
    s_call_b64 s[90:91], L_epi
    s_waitcnt vmcnt(7)
    v_dot2c_f32_bf16 v8, v96, v26
    v_dot2c_f32_bf16 v9, v96, v48
    v_dot2c_f32_bf16 v10, v97, v26
    v_dot2c_f32_bf16 v11, v97, v48
    v_dot2c_f32_bf16 v12, v98, v26
    v_dot2c_f32_bf16 v13, v98, v48
    v_dot2c_f32_bf16 v14, v99, v26
    v_dot2c_f32_bf16 v15, v99, v48
    s_waitcnt vmcnt(6)
    v_dot2c_f32_bf16 v8, v100, v27
    v_dot2c_f32_bf16 v9, v100, v49
    v_dot2c_f32_bf16 v10, v101, v27
    v_dot2c_f32_bf16 v11, v101, v49
    v_dot2c_f32_bf16 v12, v102, v27
    v_dot2c_f32_bf16 v13, v102, v49
    v_dot2c_f32_bf16 v14, v103, v27
    v_dot2c_f32_bf16 v15, v103, v49
    s_waitcnt vmcnt(5)
    v_dot2c_f32_bf16 v8, v104, v28
    v_dot2c_f32_bf16 v9, v104, v50
    v_dot2c_f32_bf16 v10, v105, v28
    v_dot2c_f32_bf16 v11, v105, v50
    v_dot2c_f32_bf16 v12, v106, v28
    v_dot2c_f32_bf16 v13, v106, v50
    v_dot2c_f32_bf16 v14, v107, v28
    v_dot2c_f32_bf16 v15, v107, v50
    s_waitcnt vmcnt(4)
    v_dot2c_f32_bf16 v8, v108, v29
    v_dot2c_f32_bf16 v9, v108, v51
    v_dot2c_f32_bf16 v10, v109, v29
    v_dot2c_f32_bf16 v11, v109, v51
    v_dot2c_f32_bf16 v12, v110, v29
    v_dot2c_f32_bf16 v13, v110, v51
    v_dot2c_f32_bf16 v14, v111, v29
    v_dot2c_f32_bf16 v15, v111, v51
L_l41:
    s_waitcnt vmcnt(3)
    v_dot2c_f32_bf16 v8, v112, v30
    v_dot2c_f32_bf16 v9, v112, v52
    v_dot2c_f32_bf16 v10, v113, v30
    v_dot2c_f32_bf16 v11, v113, v52
    v_dot2c_f32_bf16 v12, v114, v30
    v_dot2c_f32_bf16 v13, v114, v52
    v_dot2c_f32_bf16 v14, v115, v30
    v_dot2c_f32_bf16 v15, v115, v52
    s_waitcnt vmcnt(2)
    v_dot2c_f32_bf16 v8, v116, v31
    v_dot2c_f32_bf16 v9, v116, v53
    v_dot2c_f32_bf16 v10, v117, v31
    v_dot2c_f32_bf16 v11, v117, v53
    v_dot2c_f32_bf16 v12, v118, v31
    v_dot2c_f32_bf16 v13, v118, v53
    v_dot2c_f32_bf16 v14, v119, v31
    v_dot2c_f32_bf16 v15, v119, v53
    s_waitcnt vmcnt(1)
    v_dot2c_f32_bf16 v8, v120, v32
    v_dot2c_f32_bf16 v9, v120, v54
    v_dot2c_f32_bf16 v10, v121, v32
    v_dot2c_f32_bf16 v11, v121, v54
    v_dot2c_f32_bf16 v12, v122, v32
    v_dot2c_f32_bf16 v13, v122, v54
    v_dot2c_f32_bf16 v14, v123, v32
    v_dot2c_f32_bf16 v15, v123, v54
    s_waitcnt vmcnt(0)
    v_dot2c_f32_bf16 v8, v124, v33
    v_dot2c_f32_bf16 v9, v124, v55
    v_dot2c_f32_bf16 v10, v125, v33
    v_dot2c_f32_bf16 v11, v125, v55
    v_dot2c_f32_bf16 v12, v126, v33
    v_dot2c_f32_bf16 v13, v126, v55
    v_dot2c_f32_bf16 v14, v127, v33
    v_dot2c_f32_bf16 v15, v127, v55
L_done:
    v_permlane32_swap_b32 v8, v12
    v_permlane32_swap_b32 v9, v13
    v_permlane32_swap_b32 v10, v14
    v_permlane32_swap_b32 v11, v15
    v_mul_f32 v8, v8, v19
    v_mul_f32 v9, v9, v19
    v_mul_f32 v10, v10, v19
    v_mul_f32 v11, v11, v19
    v_fmac_f32 v8, v12, v18
    v_fmac_f32 v10, v14, v18
    v_fmac_f32 v9, v13, v18
    v_fmac_f32 v11, v15, v18
    v_permlane16_swap_b32 v8, v10
    s_nop 0
    v_permlane16_swap_b32 v9, v11
    v_add_f32 v8, v8, v10
    v_add_f32 v9, v9, v11
    v_cvt_pk_bf16_f32 v8, v8, v9
    ds_write_b32 v3, v8
    s_waitcnt lgkmcnt(0)
    s_barrier
    s_cmp_ge_u32 s5, 2
    s_cbranch_scc1 L_end
    s_call_b64 s[90:91], L_reduce
    s_cmp_lg_u32 s2, 0
    s_cbranch_scc1 L_noep
    s_barrier
    s_cmp_lg_u32 s5, 1
    s_cbranch_scc1 L_noep
    v_mov_b32 v30, 0x18000
    v_mov_b32 v31, s88
    s_mov_b64 exec, 0x1
    global_store_dword v30, v31, s[40:41] sc1
    s_mov_b64 exec, -1
L_noep:
    s_endpgm
L_aux:
    s_memrealtime s[86:87]
    s_and_b32 s6, s2, 7
    s_lshl_b32 s6, s6, 1
    s_bfe_u32 s7, s2, 0x10003
    s_or_b32 s6, s6, s7
    s_andn2_b32 s2, s2, 15
    s_or_b32 s2, s2, s6
    s_and_b32 s4, s2, 0xc1
    s_bfe_u32 s6, s2, 0x10001
    s_lshl_b32 s6, s6, 1
    s_or_b32 s4, s4, s6
    s_bfe_u32 s6, s2, 0x10005
    s_lshl_b32 s6, s6, 2
    s_or_b32 s4, s4, s6
    s_bfe_u32 s6, s2, 0x10003
    s_lshl_b32 s6, s6, 3
    s_or_b32 s4, s4, s6
    s_bfe_u32 s6, s2, 0x10002
    s_lshl_b32 s6, s6, 4
    s_or_b32 s4, s4, s6
    s_bfe_u32 s6, s2, 0x10004
    s_lshl_b32 s6, s6, 5
    s_or_b32 s4, s4, s6
    v_lshlrev_b32 v2, 4, v0
    v_lshrrev_b32 v1, 4, v0
    s_mov_b32 s54, 0x3e0293ee
    s_mov_b32 s55, 0xbe0293ee
    s_mov_b32 s11, 0x20000
    s_mov_b32 s15, 0x20000
    s_mov_b32 s47, 0x20000
    s_lshr_b32 s64, s2, 6
    s_lshr_b32 s65, s4, 1
    s_and_b32 s65, s65, 31
L_noctr:
    s_lshl_b32 s6, s2, 3
    s_or_b32 s6, s6, s5
    s_cmp_lg_u32 s6, 1
    s_cbranch_scc1 L_nork
    s_mov_b32 s6, 0x410000
    v_lshl_add_u32 v7, v0, 12, s6
    v_mov_b32 v63, 0
    s_mov_b64 exec, 0xff
    global_store_dword v7, v63, s[40:41] sc1
    s_mov_b64 exec, -1
L_nork:
    s_mul_i32 s94, s5, 9216
    v_add_u32 v60, s94, v2
    v_lshrrev_b32 v61, 2, v0
    v_lshlrev_b32 v61, 7, v61
    v_and_b32 v4, 3, v0
    v_lshl_add_u32 v61, v4, 3, v61
    v_lshlrev_b32 v4, 9, v1
    v_add3_u32 v61, v61, v4, s94
    s_lshl_b32 s6, s5, 10
    v_and_b32 v62, 0xf0, v2
    v_lshl_add_u32 v62, v1, 6, v62
    v_add_u32 v62, s6, v62
    s_mov_b32 s6, 0x000f000f
    s_mov_b32 s7, 0x000f000f
    s_lshl_b32 s43, s65, 17
    s_add_u32 s44, s24, s43
    s_addc_u32 s45, s25, 0
    s_mov_b32 s46, 0x20000
    s_waitcnt vmcnt(4)
    ds_write_b128 v60, v[32:35] offset:23808
    s_waitcnt vmcnt(3)
    ds_write_b128 v60, v[36:39] offset:24832
    s_waitcnt vmcnt(2)
    ds_write_b128 v60, v[40:43] offset:25856
    s_waitcnt vmcnt(1)
    ds_write_b128 v60, v[44:47] offset:26880
    ds_read_b64_tr_b16 v[32:33], v61 offset:23808
    ds_read_b64_tr_b16 v[34:35], v61 offset:24320
    ds_read_b64_tr_b16 v[36:37], v61 offset:23840
    ds_read_b64_tr_b16 v[38:39], v61 offset:24352
    ds_read_b64_tr_b16 v[40:41], v61 offset:23872
    ds_read_b64_tr_b16 v[42:43], v61 offset:24384
    ds_read_b64_tr_b16 v[44:45], v61 offset:23904
    ds_read_b64_tr_b16 v[46:47], v61 offset:24416
    s_waitcnt vmcnt(0) lgkmcnt(0)
    v_mfma_f32_16x16x32_bf16 v[8:11], v[32:35], v[48:51], 0
    v_mfma_f32_16x16x32_bf16 v[12:15], v[36:39], v[48:51], 0
    v_mfma_f32_16x16x32_bf16 v[16:19], v[40:43], v[48:51], 0
    v_mfma_f32_16x16x32_bf16 v[20:23], v[44:47], v[48:51], 0
    s_mul_i32 s88, s88, 0x9E3779B1
    s_add_u32 s88, s88, 0x7F4A7C15
    v_mov_b32 v30, 21504
    v_mov_b32 v31, 1
    s_mov_b64 exec, s[6:7]
    ds_write_b128 v62, v[8:11] offset:0
    ds_write_b128 v62, v[12:15] offset:256
    ds_write_b128 v62, v[16:19] offset:512
    ds_write_b128 v62, v[20:23] offset:768
    s_mov_b64 exec, 1
    ds_add_u32 v30, v31
    s_mov_b64 exec, -1
    s_cmp_lg_u32 s5, 0
    s_cbranch_scc1 L_nopub
    s_bfe_u32 s6, s2, 0x10003
    s_lshl_b32 s6, s6, 18
    s_lshr_b32 s7, s69, 1
    s_lshl_b32 s7, s7, 11
    s_add_u32 s6, s6, s7
    s_lshr_b32 s7, s2, 7
    s_lshl_b32 s7, s7, 10
    s_add_u32 s6, s6, s7
    s_and_b32 s7, s69, 1
    s_lshl_b32 s7, s7, 9
    s_add_u32 s6, s6, s7
    s_add_u32 s6, s6, 0x100100
    v_and_b32 v1, 3, v0
    v_lshlrev_b32 v1, 16, v1
    v_and_b32 v12, 60, v0
    v_lshl_add_u32 v1, v12, 2, v1
    v_add_u32 v1, s6, v1
    s_mov_b32 s43, 8
    s_call_b64 s[90:91], L_auxwait
    ds_read_b128 v[16:19], v2 offset:0
    ds_read_b128 v[20:23], v2 offset:1024
    ds_read_b128 v[24:27], v2 offset:2048
    ds_read_b128 v[28:31], v2 offset:3072
    ds_read_b128 v[32:35], v2 offset:4096
    ds_read_b128 v[36:39], v2 offset:5120
    ds_read_b128 v[40:43], v2 offset:6144
    ds_read_b128 v[44:47], v2 offset:7168
    s_mov_b32 s6, 0x05030201
    s_mov_b32 s7, 0x06050302
    s_mov_b32 s43, 0x07060503
    v_mov_b32 v11, s88
    s_waitcnt lgkmcnt(0)
    v_add_f32 v16, v16, v20
    v_add_f32 v17, v17, v21
    v_add_f32 v18, v18, v22
    v_add_f32 v19, v19, v23
    v_add_f32 v24, v24, v28
    v_add_f32 v25, v25, v29
    v_add_f32 v26, v26, v30
    v_add_f32 v27, v27, v31
    v_add_f32 v32, v32, v36
    v_add_f32 v33, v33, v37
    v_add_f32 v34, v34, v38
    v_add_f32 v35, v35, v39
    v_add_f32 v40, v40, v44
    v_add_f32 v41, v41, v45
    v_add_f32 v42, v42, v46
    v_add_f32 v43, v43, v47
    v_add_f32 v16, v16, v24
    v_add_f32 v17, v17, v25
    v_add_f32 v18, v18, v26
    v_add_f32 v19, v19, v27
    v_add_f32 v32, v32, v40
    v_add_f32 v33, v33, v41
    v_add_f32 v34, v34, v42
    v_add_f32 v35, v35, v43
    v_add_f32 v16, v16, v32
    v_add_f32 v17, v17, v33
    v_add_f32 v18, v18, v34
    v_add_f32 v19, v19, v35
    v_perm_b32 v8, v17, v16, s6
    v_perm_b32 v9, v18, v17, s7
    v_perm_b32 v10, v19, v18, s43
    global_store_dwordx4 v1, v[8:11], s[40:41] sc1
L_nopub:
    s_nop 2
    s_cmp_lg_u32 s5, 2
    s_cbranch_scc1 L_noqa
    s_lshl_b32 s57, s64, 5
    s_add_u32 s57, s57, s65
    s_mov_b32 s58, 20224
    s_call_b64 s[90:91], L_gatherq
    v_mov_b32 v30, 21508
    v_mov_b32 v31, 1
    v_mov_b32 v32, s88
    ds_write_b32 v30, v32 offset:12
    ds_write_b32 v30, v31
L_noqa:
    s_setprio 3
    s_lshr_b32 s67, s2, 1
    s_mov_b32 s92, 0
    s_call_b64 s[90:91], L_loadwo
    s_cmp_lg_u32 s5, 4
    s_cbranch_scc1 L_skw
    v_mov_b32 v30, 2
    v_mov_b32 v31, 21515
    ds_write_b8 v31, v30
L_skw:
    s_bitcmp1_b32 s2, 0
    s_cbranch_scc1 L_odd
    s_and_b32 s66, s67, 7
    s_lshr_b32 s68, s67, 3
    s_and_b32 s68, s68, 3
    s_lshl_b32 s6, s64, 3
    s_add_u32 s89, s6, s66
    s_lshl_b32 s6, s89, 20
    s_lshl_b32 s7, s68, 16
    s_add_u32 s6, s6, s7
    s_add_u32 s6, s6, 0xC0000
    s_add_u32 s8, s28, s6
    s_addc_u32 s9, s29, 0
    s_add_u32 s12, s30, s6
    s_addc_u32 s13, s31, 0
    s_mov_b32 s10, 0x10000
    s_mov_b32 s14, 0x10000
    s_lshl_b32 s89, s89, 2
    s_add_u32 s89, s89, s5
    s_lshl_b32 s48, s5, 13
    s_add_u32 s49, s48, 0x1000
    s_add_u32 s50, s94, 23808
    s_add_u32 s51, s50, 0x1000
    v_and_b32 v1, 48, v0
    v_and_b32 v29, 0xf0, v2
    v_xor_b32 v28, v29, v1
    v_lshl_add_u32 v24, v1, 4, v28
    v_xor_b32 v25, 64, v24
    v_xor_b32 v26, 128, v24
    v_xor_b32 v27, 192, v24
    v_lshl_add_u32 v28, v29, 4, v28
    v_mov_b32 v30, 21512
L_wbat:
    ds_read_u16 v31, v30
    s_waitcnt lgkmcnt(0)
    v_readfirstlane_b32 s6, v31
    s_nop 0
    s_cmp_ge_u32 s6, 65
    s_cbranch_scc1 L_wbat_ok
    s_sleep 8
    s_branch L_wbat
L_wbat_ok:
    s_cmp_lg_u32 s5, 4
    s_cbranch_scc1 L_ska
    v_mov_b32 v30, 8
    v_mov_b32 v31, 21515
    ds_write_b8 v31, v30
L_ska:
    s_mov_b32 m0, s50
    s_nop 0
    buffer_load_dwordx4 v24, s[8:11], s48 offen offset:0 nt lds
    buffer_load_dwordx4 v[32:35], v2, s[12:15], s48 offen offset:0 nt
    buffer_load_dwordx4 v25, s[8:11], s48 offen offset:1024 nt lds
    buffer_load_dwordx4 v[36:39], v2, s[12:15], s48 offen offset:1024 nt
    buffer_load_dwordx4 v26, s[8:11], s48 offen offset:2048 nt lds
    buffer_load_dwordx4 v[40:43], v2, s[12:15], s48 offen offset:2048 nt
    buffer_load_dwordx4 v27, s[8:11], s48 offen offset:3072 nt lds
    buffer_load_dwordx4 v[44:47], v2, s[12:15], s48 offen offset:3072 nt
    s_mov_b32 m0, s51
    s_waitcnt vmcnt(7)
    buffer_load_dwordx4 v24, s[8:11], s49 offen offset:0 nt lds
    s_waitcnt vmcnt(7)
    buffer_load_dwordx4 v[48:51], v2, s[12:15], s49 offen offset:0 nt
    s_waitcnt vmcnt(7)
    buffer_load_dwordx4 v25, s[8:11], s49 offen offset:1024 nt lds
    s_waitcnt vmcnt(7)
    buffer_load_dwordx4 v[52:55], v2, s[12:15], s49 offen offset:1024 nt
    s_waitcnt vmcnt(7)
    buffer_load_dwordx4 v26, s[8:11], s49 offen offset:2048 nt lds
    s_waitcnt vmcnt(7)
    buffer_load_dwordx4 v[56:59], v2, s[12:15], s49 offen offset:2048 nt
    s_waitcnt vmcnt(7)
    buffer_load_dwordx4 v27, s[8:11], s49 offen offset:3072 nt lds
    s_waitcnt vmcnt(7)
    buffer_load_dwordx4 v[60:63], v2, s[12:15], s49 offen offset:3072 nt
    s_cmp_lg_u32 s5, 4
    s_cbranch_scc1 L_skb
    v_mov_b32 v30, 2
    v_mov_b32 v31, 21515
    ds_write_b8 v31, v30
L_skb:
    s_cmp_lt_u32 s5, 4
    s_cbranch_scc1 L_noqb
    s_add_u32 s57, s89, 124
    s_lshl_b32 s58, s5, 8
    s_add_u32 s58, s58, 19456
    s_call_b64 s[90:91], L_gatherq0
L_noqb:
    s_mov_b32 s43, 8
    s_call_b64 s[90:91], L_auxsync
    v_and_b32 v4, 3, v0
    v_and_b32 v1, 48, v0
    v_lshl_add_u32 v5, v4, 8, v1
    v_mul_u32_u24 v6, 18, v1
    v_add3_u32 v6, v6, v29, s94
    v_lshrrev_b32 v7, 2, v0
    v_mul_u32_u24 v7, 288, v7
    v_lshl_add_u32 v7, v4, 3, v7
    v_add_u32 v7, s94, v7
    s_waitcnt vmcnt(0)
    s_mov_b32 s6, 0
    v_mov_b32 v31, s94
    v_xad_u32 v30, v28, s6, v31
    ds_read_b128 v[8:11], v5 offset:20480
    ds_read_b128 v[12:15], v30 offset:23808
    ds_read_b128 v[16:19], v30 offset:27904
    s_waitcnt lgkmcnt(0)
    v_mfma_f32_16x16x32_bf16 v[20:23], v[12:15], v[8:11], 0
    v_mfma_f32_16x16x32_bf16 v[24:27], v[16:19], v[8:11], 0
    s_nop 3
    s_mov_b32 s6, 64
    v_mov_b32 v31, s94
    v_xad_u32 v30, v28, s6, v31
    ds_read_b128 v[8:11], v5 offset:20544
    ds_read_b128 v[12:15], v30 offset:23808
    ds_read_b128 v[16:19], v30 offset:27904
    s_waitcnt lgkmcnt(0)
    v_mfma_f32_16x16x32_bf16 v[20:23], v[12:15], v[8:11], v[20:23]
    v_mfma_f32_16x16x32_bf16 v[24:27], v[16:19], v[8:11], v[24:27]
    s_nop 3
    s_mov_b32 s6, 128
    v_mov_b32 v31, s94
    v_xad_u32 v30, v28, s6, v31
    ds_read_b128 v[8:11], v5 offset:20608
    ds_read_b128 v[12:15], v30 offset:23808
    ds_read_b128 v[16:19], v30 offset:27904
    s_waitcnt lgkmcnt(0)
    v_mfma_f32_16x16x32_bf16 v[20:23], v[12:15], v[8:11], v[20:23]
    v_mfma_f32_16x16x32_bf16 v[24:27], v[16:19], v[8:11], v[24:27]
    s_nop 3
    s_mov_b32 s6, 192
    v_mov_b32 v31, s94
    v_xad_u32 v30, v28, s6, v31
    ds_read_b128 v[8:11], v5 offset:20672
    ds_read_b128 v[12:15], v30 offset:23808
    ds_read_b128 v[16:19], v30 offset:27904
    s_waitcnt lgkmcnt(0)
    v_mfma_f32_16x16x32_bf16 v[20:23], v[12:15], v[8:11], v[20:23]
    v_mfma_f32_16x16x32_bf16 v[24:27], v[16:19], v[8:11], v[24:27]
    s_nop 3
    ds_write_b128 v6, v[32:35] offset:23808
    ds_write_b128 v6, v[36:39] offset:24960
    ds_write_b128 v6, v[40:43] offset:26112
    ds_write_b128 v6, v[44:47] offset:27264
    ds_write_b128 v6, v[48:51] offset:28416
    ds_write_b128 v6, v[52:55] offset:29568
    ds_write_b128 v6, v[56:59] offset:30720
    ds_write_b128 v6, v[60:63] offset:31872
    v_max3_f32 v28, v20, v21, v22
    v_max3_f32 v29, v23, v24, v25
    v_max3_f32 v28, v28, v26, v27
    v_max_f32 v28, v28, v29
    v_mov_b32 v29, v28
    s_nop 1
    v_permlane32_swap_b32 v28, v29
    v_max_f32 v28, v28, v29
    v_mov_b32 v29, v28
    s_nop 1
    v_permlane16_swap_b32 v28, v29
    v_max_f32 v28, v28, v29
    v_mul_f32 v30, s55, v28
    v_mul_f32 v28, s54, v28
    v_fma_f32 v20, v20, s54, v30
    v_fma_f32 v21, v21, s54, v30
    v_fma_f32 v22, v22, s54, v30
    v_fma_f32 v23, v23, s54, v30
    v_fma_f32 v24, v24, s54, v30
    v_fma_f32 v25, v25, s54, v30
    v_fma_f32 v26, v26, s54, v30
    v_fma_f32 v27, v27, s54, v30
    v_exp_f32 v20, v20
    v_exp_f32 v21, v21
    v_exp_f32 v22, v22
    v_exp_f32 v23, v23
    v_exp_f32 v24, v24
    v_exp_f32 v25, v25
    v_exp_f32 v26, v26
    v_exp_f32 v27, v27
    s_mov_b32 s6, 0x3f803f80
    v_cvt_pk_bf16_f32 v27, v26, v27
    v_cvt_pk_bf16_f32 v26, v24, v25
    v_cvt_pk_bf16_f32 v24, v20, v21
    v_cvt_pk_bf16_f32 v25, v22, v23
    v_dot2_f32_bf16 v29, v24, s6, 0
    v_dot2_f32_bf16 v29, v25, s6, v29
    v_dot2_f32_bf16 v29, v26, s6, v29
    v_dot2_f32_bf16 v29, v27, s6, v29
    s_nop 2
    v_mov_b32 v30, v29
    s_nop 1
    v_permlane32_swap_b32 v29, v30
    v_add_f32 v29, v29, v30
    v_mov_b32 v30, v29
    s_nop 1
    v_permlane16_swap_b32 v29, v30
    v_add_f32 v29, v29, v30
    s_lshl_b32 s6, s5, 3
    v_lshl_add_u32 v30, v4, 6, s6
    ds_write_b64 v30, v[28:29] offset:19712
    s_lshl_b32 s6, s5, 8
    v_lshrrev_b32 v1, 1, v1
    v_lshl_add_u32 v5, v4, 11, v1
    v_add_u32 v5, s6, v5
    ds_read_b64_tr_b16 v[8:9], v7 offset:23808
    ds_read_b64_tr_b16 v[10:11], v7 offset:28416
    ds_read_b64_tr_b16 v[12:13], v7 offset:23840
    ds_read_b64_tr_b16 v[14:15], v7 offset:28448
    ds_read_b64_tr_b16 v[16:17], v7 offset:23872
    ds_read_b64_tr_b16 v[18:19], v7 offset:28480
    ds_read_b64_tr_b16 v[20:21], v7 offset:23904
    ds_read_b64_tr_b16 v[22:23], v7 offset:28512
    s_waitcnt lgkmcnt(6)
    v_mfma_f32_16x16x32_bf16 v[32:35], v[8:11], v[24:27], 0
    s_waitcnt lgkmcnt(4)
    v_mfma_f32_16x16x32_bf16 v[36:39], v[12:15], v[24:27], 0
    s_waitcnt lgkmcnt(2)
    v_mfma_f32_16x16x32_bf16 v[40:43], v[16:19], v[24:27], 0
    s_waitcnt lgkmcnt(0)
    v_mfma_f32_16x16x32_bf16 v[44:47], v[20:23], v[24:27], 0
    s_nop 3
    ds_read_b64_tr_b16 v[8:9], v7 offset:23936
    ds_read_b64_tr_b16 v[10:11], v7 offset:28544
    ds_read_b64_tr_b16 v[12:13], v7 offset:23968
    ds_read_b64_tr_b16 v[14:15], v7 offset:28576
    ds_read_b64_tr_b16 v[16:17], v7 offset:24000
    ds_read_b64_tr_b16 v[18:19], v7 offset:28608
    ds_read_b64_tr_b16 v[20:21], v7 offset:24032
    ds_read_b64_tr_b16 v[22:23], v7 offset:28640
    s_waitcnt lgkmcnt(6)
    v_mfma_f32_16x16x32_bf16 v[48:51], v[8:11], v[24:27], 0
    s_waitcnt lgkmcnt(4)
    v_mfma_f32_16x16x32_bf16 v[52:55], v[12:15], v[24:27], 0
    s_waitcnt lgkmcnt(2)
    v_mfma_f32_16x16x32_bf16 v[56:59], v[16:19], v[24:27], 0
    s_waitcnt lgkmcnt(0)
    v_mfma_f32_16x16x32_bf16 v[60:63], v[20:23], v[24:27], 0
    s_nop 3
    v_cvt_pk_bf16_f32 v32, v32, v33
    v_cvt_pk_bf16_f32 v33, v34, v35
    v_cvt_pk_bf16_f32 v36, v36, v37
    v_cvt_pk_bf16_f32 v37, v38, v39
    v_cvt_pk_bf16_f32 v40, v40, v41
    v_cvt_pk_bf16_f32 v41, v42, v43
    v_cvt_pk_bf16_f32 v44, v44, v45
    v_cvt_pk_bf16_f32 v45, v46, v47
    v_cvt_pk_bf16_f32 v48, v48, v49
    v_cvt_pk_bf16_f32 v49, v50, v51
    v_cvt_pk_bf16_f32 v52, v52, v53
    v_cvt_pk_bf16_f32 v53, v54, v55
    v_cvt_pk_bf16_f32 v56, v56, v57
    v_cvt_pk_bf16_f32 v57, v58, v59
    v_cvt_pk_bf16_f32 v60, v60, v61
    v_cvt_pk_bf16_f32 v61, v62, v63
    s_mov_b32 s6, 0x000f000f
    s_mov_b32 s7, 0x000f000f
    s_mov_b64 exec, s[6:7]
    ds_write_b64 v5, v[32:33] offset:0
    ds_write_b64 v5, v[36:37] offset:32
    ds_write_b64 v5, v[40:41] offset:64
    ds_write_b64 v5, v[44:45] offset:96
    ds_write_b64 v5, v[48:49] offset:128
    ds_write_b64 v5, v[52:53] offset:160
    ds_write_b64 v5, v[56:57] offset:192
    ds_write_b64 v5, v[60:61] offset:224
    v_mov_b32 v30, 21516
    v_mov_b32 v31, 1
    s_mov_b64 exec, 1
    ds_add_u32 v30, v31
    s_mov_b64 exec, -1
    v_mov_b32 v30, 21516
    s_cmp_ge_u32 s5, 4
    s_cbranch_scc1 L_join
    s_mov_b32 s43, 16
    s_call_b64 s[90:91], L_auxwait
    v_lshrrev_b32 v1, 5, v0
    s_lshl_b32 s6, s5, 6
    v_lshl_add_u32 v4, v1, 5, s6
    v_and_b32 v5, 31, v0
    v_lshlrev_b32 v6, 3, v5
    v_lshl_add_u32 v6, v1, 10, v6
    s_lshl_b32 s6, s5, 11
    v_add_u32 v6, s6, v6
    ds_read_b128 v[16:19], v4 offset:19712
    ds_read_b128 v[20:23], v4 offset:19728
    ds_read_b64 v[32:33], v6 offset:0
    ds_read_b64 v[34:35], v6 offset:256
    ds_read_b64 v[36:37], v6 offset:512
    ds_read_b64 v[38:39], v6 offset:768
    s_lshl_b32 s6, s89, 2
    s_add_u32 s6, s6, s68
    s_lshl_b32 s6, s6, 9
    s_add_u32 s6, s6, 0x40000
    v_add_u32 v7, s6, v2
    s_waitcnt lgkmcnt(0)
    v_max3_f32 v12, v16, v18, v20
    v_max_f32 v12, v12, v22
    v_mov_b32 v13, v12
    s_nop 1
    v_permlane32_swap_b32 v12, v13
    v_max_f32 v12, v12, v13
    v_sub_f32 v16, v16, v12
    v_sub_f32 v18, v18, v12
    v_sub_f32 v20, v20, v12
    v_sub_f32 v22, v22, v12
    v_exp_f32 v16, v16
    v_exp_f32 v18, v18
    v_exp_f32 v20, v20
    v_exp_f32 v22, v22
    v_mul_f32 v13, v16, v17
    v_fmac_f32 v13, v18, v19
    v_fmac_f32 v13, v20, v21
    v_fmac_f32 v13, v22, v23
    v_mov_b32 v14, v13
    s_nop 1
    v_permlane32_swap_b32 v13, v14
    v_add_f32 v13, v13, v14
    v_lshlrev_b32 v4, 16, v32
    v_and_b32 v32, 0xffff0000, v32
    v_lshlrev_b32 v5, 16, v33
    v_and_b32 v33, 0xffff0000, v33
    v_mul_f32 v8, v16, v4
    v_mul_f32 v9, v16, v32
    v_mul_f32 v10, v16, v5
    v_mul_f32 v11, v16, v33
    v_lshlrev_b32 v4, 16, v34
    v_and_b32 v34, 0xffff0000, v34
    v_lshlrev_b32 v5, 16, v35
    v_and_b32 v35, 0xffff0000, v35
    v_fmac_f32 v8, v18, v4
    v_fmac_f32 v9, v18, v34
    v_fmac_f32 v10, v18, v5
    v_fmac_f32 v11, v18, v35
    v_lshlrev_b32 v4, 16, v36
    v_and_b32 v36, 0xffff0000, v36
    v_lshlrev_b32 v5, 16, v37
    v_and_b32 v37, 0xffff0000, v37
    v_fmac_f32 v8, v20, v4
    v_fmac_f32 v9, v20, v36
    v_fmac_f32 v10, v20, v5
    v_fmac_f32 v11, v20, v37
    v_lshlrev_b32 v4, 16, v38
    v_and_b32 v38, 0xffff0000, v38
    v_lshlrev_b32 v5, 16, v39
    v_and_b32 v39, 0xffff0000, v39
    v_fmac_f32 v8, v22, v4
    v_fmac_f32 v9, v22, v38
    v_fmac_f32 v10, v22, v5
    v_fmac_f32 v11, v22, v39
    v_log_f32 v14, v13
    v_rcp_f32 v13, v13
    v_permlane32_swap_b32 v8, v10
    v_permlane32_swap_b32 v9, v11
    v_add_f32 v8, v8, v10
    v_add_f32 v9, v9, v11
    v_mul_f32 v8, v8, v13
    v_mul_f32 v9, v9, v13
    v_add_f32 v11, v12, v14
    v_mov_b32 v10, s88
    v_cvt_pk_bf16_f32 v8, v8, v9
    v_mov_b32 v9, v8
    s_nop 1
    v_permlane32_swap_b32 v8, v9
    s_mov_b64 exec, 0xffffffff
    global_store_dwordx4 v7, v[8:11], s[40:41] sc1
    s_mov_b64 exec, -1
    s_branch L_join
L_odd:
    s_and_b32 s66, s67, 7
    s_lshl_b32 s66, s66, 2
    s_bfe_u32 s6, s67, 0x20003
    s_or_b32 s66, s66, s6
    s_lshr_b32 s68, s67, 5
    s_lshl_b32 s6, s66, 17
    s_add_u32 s44, s34, s6
    s_addc_u32 s45, s35, 0
    v_and_b32 v1, 48, v0
    v_and_b32 v29, 0xf0, v2
    v_lshl_add_u32 v63, v1, 6, v29
    v_mul_u32_u24 v60, 18, v1
    v_add3_u32 v60, v60, v29, s94
    s_lshl_b32 s43, s5, 14
    s_lshl_b32 s6, s68, 8
    s_add_u32 s43, s43, s6
    v_mov_b32 v30, 21512
L_wwat:
    ds_read_u16 v31, v30
    s_waitcnt lgkmcnt(0)
    v_readfirstlane_b32 s6, v31
    s_nop 0
    s_cmp_ge_u32 s6, 69
    s_cbranch_scc1 L_wwat_ok
    s_sleep 8
    s_branch L_wwat
L_wwat_ok:
    buffer_load_dwordx4 v[32:35], v63, s[44:47], s43 offen nt
    s_add_u32 s43, s43, 0x1000
    buffer_load_dwordx4 v[36:39], v63, s[44:47], s43 offen nt
    s_add_u32 s43, s43, 0x1000
    buffer_load_dwordx4 v[40:43], v63, s[44:47], s43 offen nt
    s_add_u32 s43, s43, 0x1000
    buffer_load_dwordx4 v[44:47], v63, s[44:47], s43 offen nt
    s_waitcnt vmcnt(3)
    ds_write_b128 v60, v[32:35] offset:23808
    s_waitcnt vmcnt(2)
    ds_write_b128 v60, v[36:39] offset:24960
    s_waitcnt vmcnt(1)
    ds_write_b128 v60, v[40:43] offset:26112
    s_waitcnt vmcnt(0)
    ds_write_b128 v60, v[44:47] offset:27264
    s_cmp_ge_u32 s5, 4
    s_cbranch_scc1 L_nogo
    s_lshl_b32 s7, s5, 5
    s_add_u32 s7, s7, s66
    s_mul_i32 s56, s5, 272
    s_lshl_b32 s7, s7, 11
    s_add_u32 s7, s7, 0x40000
    v_add_u32 v7, s7, v2
    v_and_b32 v6, 31, v0
    v_lshlrev_b32 v6, 3, v6
    v_lshrrev_b32 v1, 5, v0
    v_lshl_add_u32 v6, v1, 2, v6
    v_add_u32 v6, s56, v6
    v_mov_b32 v30, 21512
L_wob:
    ds_read_u16 v31, v30
    s_waitcnt lgkmcnt(0)
    v_readfirstlane_b32 s6, v31
    s_nop 0
    s_cmp_ge_u32 s6, 108
    s_cbranch_scc1 L_wob_ok
    s_sleep 32
    s_branch L_wob
L_wob_ok:
    global_load_dwordx4 v[8:11], v7, s[40:41]
    global_load_dwordx4 v[12:15], v7, s[40:41] offset:1024
    s_mov_b32 s42, 0x100000
L_go_chk:
    s_waitcnt vmcnt(0)
    v_xor_b32 v16, s88, v10
    v_xor_b32 v17, s88, v14
    v_or_b32 v16, v16, v17
    v_cmp_ne_u32 vcc, 0, v16
    s_sub_u32 s42, s42, 1
    s_cmp_eq_u32 s42, 0
    s_cbranch_scc1 L_go_ok
    s_cbranch_vccz L_go_ok
    s_sleep 16
    global_load_dwordx4 v[8:11], v7, s[40:41] sc1
    global_load_dwordx4 v[12:15], v7, s[40:41] offset:1024 sc1
    s_branch L_go_chk
L_go_ok:
    v_max_f32 v16, v11, v15
    v_mov_b32 v17, v16
    s_nop 1
    v_permlane32_swap_b32 v16, v17
    v_max_f32 v16, v16, v17
    v_sub_f32 v11, v11, v16
    v_sub_f32 v15, v15, v16
    v_exp_f32 v11, v11
    v_exp_f32 v15, v15
    s_nop 0
    v_add_f32 v16, v11, v15
    v_mov_b32 v17, v16
    s_nop 1
    v_permlane32_swap_b32 v16, v17
    v_add_f32 v16, v16, v17
    v_lshlrev_b32 v4, 16, v8
    v_and_b32 v8, 0xffff0000, v8
    v_lshlrev_b32 v5, 16, v9
    v_and_b32 v9, 0xffff0000, v9
    v_mul_f32 v20, v11, v4
    v_mul_f32 v21, v11, v8
    v_mul_f32 v22, v11, v5
    v_mul_f32 v23, v11, v9
    v_lshlrev_b32 v4, 16, v12
    v_and_b32 v12, 0xffff0000, v12
    v_lshlrev_b32 v5, 16, v13
    v_and_b32 v13, 0xffff0000, v13
    v_fmac_f32 v20, v15, v4
    v_fmac_f32 v21, v15, v12
    v_fmac_f32 v22, v15, v5
    v_fmac_f32 v23, v15, v13
    v_rcp_f32 v16, v16
    v_permlane32_swap_b32 v20, v22
    v_permlane32_swap_b32 v21, v23
    v_add_f32 v20, v20, v22
    v_add_f32 v21, v21, v23
    v_mul_f32 v20, v20, v16
    v_mul_f32 v21, v21, v16
    v_cvt_pk_bf16_f32 v20, v20, v21
    ds_write_b32 v6, v20 offset:21568
L_nogo:
    v_mov_b32 v30, 21516
    v_mov_b32 v31, 1
    s_mov_b64 exec, 1
    ds_add_u32 v30, v31
    s_mov_b64 exec, -1
    s_cmp_ge_u32 s5, 2
    s_cbranch_scc1 L_join
    v_lshrrev_b32 v4, 2, v0
    v_mul_u32_u24 v4, 288, v4
    v_and_b32 v1, 3, v0
    v_lshl_add_u32 v4, v1, 3, v4
    s_lshl_b32 s6, s5, 7
    v_add_u32 v4, s6, v4
    v_add_u32 v5, 36864, v4
    v_and_b32 v1, 12, v0
    v_mul_u32_u24 v6, 68, v1
    v_and_b32 v1, 48, v0
    v_lshrrev_b32 v7, 1, v1
    s_mov_b32 s6, 21568
    v_add3_u32 v6, v6, v7, s6
    s_lshl_b32 s6, s66, 12
    s_lshl_b32 s7, s68, 10
    s_add_u32 s6, s6, s7
    s_lshl_b32 s7, s5, 9
    s_add_u32 s6, s6, s7
    s_add_u32 s6, s6, 0x80000
    v_lshlrev_b32 v1, 13, v1
    v_add3_u32 v7, v29, v1, s6
    s_mov_b32 s43, 8
    s_call_b64 s[90:91], L_auxwait
    ds_read2_b64 v[56:59], v6 offset0:0 offset1:4
    ds_read_b64_tr_b16 v[8:9], v4 offset:23808
    ds_read_b64_tr_b16 v[10:11], v4 offset:33024
    ds_read_b64_tr_b16 v[12:13], v4 offset:23840
    ds_read_b64_tr_b16 v[14:15], v4 offset:33056
    ds_read_b64_tr_b16 v[16:17], v4 offset:23872
    ds_read_b64_tr_b16 v[18:19], v4 offset:33088
    ds_read_b64_tr_b16 v[20:21], v4 offset:23904
    ds_read_b64_tr_b16 v[22:23], v4 offset:33120
    ds_read2_b64 v[60:63], v6 offset0:8 offset1:12
    ds_read_b64_tr_b16 v[24:25], v4 offset:42240
    ds_read_b64_tr_b16 v[26:27], v4 offset:51456
    ds_read_b64_tr_b16 v[28:29], v4 offset:42272
    ds_read_b64_tr_b16 v[30:31], v4 offset:51488
    ds_read_b64_tr_b16 v[32:33], v4 offset:42304
    ds_read_b64_tr_b16 v[34:35], v4 offset:51520
    ds_read_b64_tr_b16 v[36:37], v4 offset:42336
    ds_read_b64_tr_b16 v[38:39], v4 offset:51552
    s_waitcnt lgkmcnt(9)
    v_mfma_f32_16x16x32_bf16 v[40:43], v[56:59], v[8:11], 0
    v_mfma_f32_16x16x32_bf16 v[44:47], v[56:59], v[12:15], 0
    v_mfma_f32_16x16x32_bf16 v[48:51], v[56:59], v[16:19], 0
    v_mfma_f32_16x16x32_bf16 v[52:55], v[56:59], v[20:23], 0
    s_nop 3
    ds_read2_b64 v[56:59], v6 offset0:16 offset1:20
    ds_read_b64_tr_b16 v[8:9], v5 offset:23808
    ds_read_b64_tr_b16 v[10:11], v5 offset:33024
    ds_read_b64_tr_b16 v[12:13], v5 offset:23840
    ds_read_b64_tr_b16 v[14:15], v5 offset:33056
    ds_read_b64_tr_b16 v[16:17], v5 offset:23872
    ds_read_b64_tr_b16 v[18:19], v5 offset:33088
    ds_read_b64_tr_b16 v[20:21], v5 offset:23904
    ds_read_b64_tr_b16 v[22:23], v5 offset:33120
    s_waitcnt lgkmcnt(9)
    v_mfma_f32_16x16x32_bf16 v[40:43], v[60:63], v[24:27], v[40:43]
    v_mfma_f32_16x16x32_bf16 v[44:47], v[60:63], v[28:31], v[44:47]
    v_mfma_f32_16x16x32_bf16 v[48:51], v[60:63], v[32:35], v[48:51]
    v_mfma_f32_16x16x32_bf16 v[52:55], v[60:63], v[36:39], v[52:55]
    s_nop 3
    ds_read2_b64 v[60:63], v6 offset0:24 offset1:28
    ds_read_b64_tr_b16 v[24:25], v5 offset:42240
    ds_read_b64_tr_b16 v[26:27], v5 offset:51456
    ds_read_b64_tr_b16 v[28:29], v5 offset:42272
    ds_read_b64_tr_b16 v[30:31], v5 offset:51488
    ds_read_b64_tr_b16 v[32:33], v5 offset:42304
    ds_read_b64_tr_b16 v[34:35], v5 offset:51520
    ds_read_b64_tr_b16 v[36:37], v5 offset:42336
    ds_read_b64_tr_b16 v[38:39], v5 offset:51552
    s_waitcnt lgkmcnt(9)
    v_mfma_f32_16x16x32_bf16 v[40:43], v[56:59], v[8:11], v[40:43]
    v_mfma_f32_16x16x32_bf16 v[44:47], v[56:59], v[12:15], v[44:47]
    v_mfma_f32_16x16x32_bf16 v[48:51], v[56:59], v[16:19], v[48:51]
    v_mfma_f32_16x16x32_bf16 v[52:55], v[56:59], v[20:23], v[52:55]
    s_nop 3
    s_waitcnt lgkmcnt(0)
    v_mfma_f32_16x16x32_bf16 v[40:43], v[60:63], v[24:27], v[40:43]
    v_mfma_f32_16x16x32_bf16 v[44:47], v[60:63], v[28:31], v[44:47]
    v_mfma_f32_16x16x32_bf16 v[48:51], v[60:63], v[32:35], v[48:51]
    v_mfma_f32_16x16x32_bf16 v[52:55], v[60:63], v[36:39], v[52:55]
    s_nop 3
    s_nop 2
    v_cvt_pk_bf16_f32 v40, v40, v48
    v_cvt_pk_bf16_f32 v41, v44, v52
    v_mov_b32 v42, s88
    v_mov_b32 v43, 0
    v_mov_b32 v3, v7
    s_mov_b32 s92, 1
L_join:
    s_nop 2
    s_cmp_lg_u32 s5, 6
    s_cbranch_scc1 L_noredB
    s_mov_b32 s93, 1
    s_mov_b32 s57, 0
    s_mov_b32 s59, 0
    s_mov_b32 s51, 2
    s_mov_b32 s53, 0
    s_call_b64 s[90:91], L_reduce
L_noredB:
    s_cmp_lg_u32 s5, 7
    s_cbranch_scc1 L_nork2
    s_bitcmp1_b32 s2, 0
    s_cselect_b32 s56, 12, 0
    s_add_u32 s56, s56, 73
    s_bfe_u32 s6, s2, 0x30004
    s_lshl_b32 s6, s6, 12
    s_add_u32 s6, s6, 0x410000
    v_mov_b32 v8, s6
    s_mov_b32 s24, 0x4050708
    s_mov_b32 s25, 0x88868202
    v_mov_b32 v30, 21512
L_wt0:
    ds_read_u16 v31, v30
    s_waitcnt lgkmcnt(0)
    v_readfirstlane_b32 s6, v31
    s_nop 0
    s_cmp_ge_u32 s6, s56
    s_cbranch_scc1 L_wt0_ok
    s_sleep 4
    s_branch L_wt0
L_wt0_ok:
    s_memrealtime s[22:23]
    s_waitcnt lgkmcnt(0)
    s_lshl_b32 s6, s22, 7
    s_add_u32 s6, s6, 1
    v_mov_b32 v9, s6
    s_mov_b64 exec, 1
    global_atomic_add v10, v8, v9, s[40:41] sc0 sc1
    s_mov_b64 exec, -1
    s_waitcnt vmcnt(0) lgkmcnt(0)
    v_readfirstlane_b32 s6, v10
    s_nop 0
    s_and_b32 s6, s6, 127
    s_lshr_b32 s6, s6, 2
    s_min_u32 s6, s6, 7
    s_lshl_b32 s6, s6, 3
    s_lshr_b64 s[22:23], s[24:25], s6
    v_mov_b32 v10, s22
    ds_write_b8 v30, v10 offset:3
L_norep:
    s_mov_b32 s24, 0x4050708
    s_mov_b32 s25, 0x88868202
    s_mov_b32 s59, 0
    s_add_u32 s57, s56, 8
    v_mov_b32 v30, 21512
L_wt1:
    ds_read_u16 v31, v30
    s_waitcnt lgkmcnt(0)
    v_readfirstlane_b32 s6, v31
    s_nop 0
    s_cmp_ge_u32 s6, s57
    s_cbranch_scc1 L_wt1_ok
    s_sleep 4
    s_branch L_wt1
L_wt1_ok:
    s_mov_b64 exec, 1
    global_load_dword v10, v8, s[40:41] sc1
    s_mov_b64 exec, -1
    s_add_u32 s57, s57, 3
    s_sub_u32 s7, s57, s56
    s_waitcnt vmcnt(0)
    v_readfirstlane_b32 s59, v10
    s_cmp_gt_u32 s7, 37
    s_cbranch_scc1 L_nork2
    s_and_b32 s6, s59, 127
    s_cmp_eq_u32 s6, 32
    s_cbranch_scc0 L_wt1
    s_mov_b32 s57, 0
    s_mov_b32 s58, 0
    s_mov_b32 s52, 232
    s_lshl_b32 s6, s86, 12
    s_sub_u32 s6, s59, s6
    s_ashr_i32 s6, s6, 12
    s_sub_u32 s6, s6, 2620
    s_mul_i32 s6, s6, 127
    s_ashr_i32 s6, s6, 10
    s_add_u32 s49, s6, 464
    s_max_i32 s49, s49, 457
    s_min_i32 s49, s49, 544
    s_mov_b32 s53, 37
    s_call_b64 s[90:91], L_em
L_nork2:
    s_lshl_b32 s6, s4, 12
    s_lshl_b32 s7, s5, 9
    s_add_u32 s6, s6, s7
    s_add_u32 s6, s6, 0x100000
    v_add_u32 v7, s6, v2
    v_and_b32 v1, 7, v0
    v_mul_u32_u24 v4, 272, v1
    v_and_b32 v1, 48, v0
    v_add_u32 v4, v4, v1
    v_and_b32 v1, 8, v0
    v_lshl_add_u32 v4, v1, 4, v4
    v_lshrrev_b32 v5, 2, v0
    v_xor_b32 v5, v5, v0
    v_and_b32 v5, 4, v5
    v_and_or_b32 v5, v0, 3, v5
    v_lshlrev_b32 v5, 3, v5
    v_cmp_eq_u32 vcc, 0, v1
    v_mov_b32 v6, 0xeeeeeeee
    v_mov_b32 v1, 0x44444444
    v_cndmask_b32 v6, v6, v1, vcc
    v_mov_b32 v62, s88
    s_mov_b32 s43, s92
    s_setprio 3
    s_cmp_eq_u32 s43, 0
    s_cbranch_scc1 L_fin1
L_fin:
    v_mov_b32 v16, 0
    v_mov_b32 v17, 0
    v_mov_b32 v18, 0
    v_mov_b32 v19, 0
    v_mov_b32 v20, 0
    v_mov_b32 v21, 0
    v_mov_b32 v22, 0
    v_mov_b32 v23, 0
    v_mov_b32 v24, 0
    v_mov_b32 v25, 0
    v_mov_b32 v26, 0
    v_mov_b32 v27, 0
    v_mov_b32 v28, 0
    v_mov_b32 v29, 0
    v_mov_b32 v30, 0
    v_mov_b32 v31, 0
    s_waitcnt lgkmcnt(0)
    s_barrier
L_fin1:
    ds_read_b64 v[32:33], v5 offset:19584
    ds_read_b128 v[8:11], v4 offset:17408
    ds_read_b128 v[12:15], v4 offset:17472
    s_cmp_eq_u32 s92, 0
    s_cbranch_scc1 L_noyb
    global_store_dwordx4 v3, v[40:43], s[40:41] sc1
L_noyb:
    s_waitcnt lgkmcnt(2)
    v_max_f32_dpp v34, v32, v32 quad_perm:[1,0,3,2] row_mask:0xf bank_mask:0xf
    s_waitcnt lgkmcnt(1)
    v_smfmac_f32_16x16x64_bf16 v[16:19], v[8:11], v[64:71], v6
    v_max_f32_dpp v34, v34, v34 quad_perm:[2,3,0,1] row_mask:0xf bank_mask:0xf
    v_smfmac_f32_16x16x64_bf16 v[20:23], v[8:11], v[72:79], v6
    s_cmp_eq_u32 s43, 0
    v_max_f32_dpp v34, v34, v34 row_ror:4 row_mask:0xf bank_mask:0xf
    v_sub_f32 v35, v32, v34
    v_smfmac_f32_16x16x64_bf16 v[24:27], v[8:11], v[80:87], v6
    v_exp_f32 v35, v35
    v_smfmac_f32_16x16x64_bf16 v[28:31], v[8:11], v[88:95], v6
    v_mul_f32 v36, v35, v33
    s_waitcnt lgkmcnt(0)
    v_smfmac_f32_16x16x64_bf16 v[16:19], v[12:15], v[96:103], v6
    v_add_f32_dpp v36, v36, v36 quad_perm:[1,0,3,2] row_mask:0xf bank_mask:0xf
    v_mov_b32_dpp v35, v35 row_ror:4 row_mask:0xf bank_mask:0xa
    v_smfmac_f32_16x16x64_bf16 v[20:23], v[12:15], v[104:111], v6
    v_add_f32_dpp v36, v36, v36 quad_perm:[2,3,0,1] row_mask:0xf bank_mask:0xf
    v_smfmac_f32_16x16x64_bf16 v[24:27], v[12:15], v[112:119], v6
    s_mov_b32 s43, 1
    v_add_f32_dpp v36, v36, v36 row_ror:4 row_mask:0xf bank_mask:0xf
    v_smfmac_f32_16x16x64_bf16 v[28:31], v[12:15], v[120:127], v6
    v_rcp_f32 v37, v36
    v_log_f32 v38, v36
    v_mul_f32 v35, v35, v37
    v_add_f32 v63, v34, v38
    s_nop 0
    v_mul_f32_dpp v16, v35, v16 quad_perm:[0,0,0,0] row_mask:0xf bank_mask:0xf
    v_mul_f32_dpp v20, v35, v20 quad_perm:[0,0,0,0] row_mask:0xf bank_mask:0xf
    v_mul_f32_dpp v24, v35, v24 quad_perm:[0,0,0,0] row_mask:0xf bank_mask:0xf
    v_mul_f32_dpp v28, v35, v28 quad_perm:[0,0,0,0] row_mask:0xf bank_mask:0xf
    v_fmac_f32_dpp v16, v35, v17 quad_perm:[1,1,1,1] row_mask:0xf bank_mask:0xf
    v_fmac_f32_dpp v20, v35, v21 quad_perm:[1,1,1,1] row_mask:0xf bank_mask:0xf
    v_fmac_f32_dpp v24, v35, v25 quad_perm:[1,1,1,1] row_mask:0xf bank_mask:0xf
    v_fmac_f32_dpp v28, v35, v29 quad_perm:[1,1,1,1] row_mask:0xf bank_mask:0xf
    v_fmac_f32_dpp v16, v35, v18 quad_perm:[2,2,2,2] row_mask:0xf bank_mask:0xf
    v_fmac_f32_dpp v20, v35, v22 quad_perm:[2,2,2,2] row_mask:0xf bank_mask:0xf
    v_fmac_f32_dpp v24, v35, v26 quad_perm:[2,2,2,2] row_mask:0xf bank_mask:0xf
    v_fmac_f32_dpp v28, v35, v30 quad_perm:[2,2,2,2] row_mask:0xf bank_mask:0xf
    v_fmac_f32_dpp v16, v35, v19 quad_perm:[3,3,3,3] row_mask:0xf bank_mask:0xf
    v_fmac_f32_dpp v20, v35, v23 quad_perm:[3,3,3,3] row_mask:0xf bank_mask:0xf
    v_fmac_f32_dpp v24, v35, v27 quad_perm:[3,3,3,3] row_mask:0xf bank_mask:0xf
    v_fmac_f32_dpp v28, v35, v31 quad_perm:[3,3,3,3] row_mask:0xf bank_mask:0xf
    v_permlane16_swap_b32 v16, v20
    v_add_f32 v17, v16, v20
    v_permlane16_swap_b32 v24, v28
    v_add_f32 v16, v16, v20
    v_add_f32 v25, v24, v28
    v_add_f32 v24, v24, v28
    v_permlane32_swap_b32 v16, v17
    v_add_f32 v16, v16, v17
    v_permlane32_swap_b32 v24, v25
    v_add_f32 v24, v24, v25
    v_cvt_pk_bf16_f32 v60, v16, v24
    v_cvt_pk_bf16_f32 v61, v16, v24
    s_cbranch_scc1 L_fin
    s_nop 0
    v_permlane16_swap_b32 v60, v61
    s_mov_b64 exec, 0xffff
    global_store_dwordx4 v7, v[60:63], s[40:41] sc1
    s_waitcnt vmcnt(0)
    s_barrier
L_end:
    s_endpgm
L_gatherq0:
    s_lshl_b32 s57, s57, 11
    s_add_u32 s57, s57, 0x100100
    v_and_b32 v30, 768, v2
    v_add3_u32 v30, v30, v2, s57
    global_load_dwordx4 v[8:11], v30, s[40:41]
    s_mov_b32 s42, 0x100000
    s_branch L_gq_chk
L_gatherq:
    s_lshl_b32 s57, s57, 11
    s_add_u32 s57, s57, 0x100100
    v_and_b32 v30, 768, v2
    v_add3_u32 v30, v30, v2, s57
    s_mov_b32 s42, 0x100000
L_gq_poll:
    global_load_dwordx4 v[8:11], v30, s[40:41] sc1
L_gq_chk:
    s_waitcnt vmcnt(0)
    v_cmp_ne_u32 vcc, s88, v11
    s_sub_u32 s42, s42, 1
    s_cmp_eq_u32 s42, 0
    s_cbranch_scc1 L_gq_go
    s_and_b64 exec, exec, vcc
    s_cbranch_execnz L_gq_poll
L_gq_go:
    s_mov_b64 exec, -1
    s_mov_b32 s6, 0x0504030c
    s_mov_b32 s7, 0x0403020c
    v_lshlrev_b32 v16, 8, v8
    v_perm_b32 v17, v9, v8, s6
    v_perm_b32 v18, v10, v9, s7
    v_and_b32 v19, 0xffffff00, v10
    v_and_b32 v31, 31, v0
    v_lshlrev_b32 v31, 3, v31
    v_lshrrev_b32 v1, 5, v0
    v_lshl_add_u32 v31, v1, 2, v31
    v_permlane32_swap_b32 v16, v18
    v_permlane32_swap_b32 v17, v19
    v_add_u32 v31, s58, v31
    v_add_f32 v16, v16, v18
    v_add_f32 v17, v17, v19
    v_cvt_pk_bf16_f32 v16, v16, v17
    ds_write_b32 v31, v16
    s_setpc_b64 s[90:91]
L_loadwo:
    v_lshrrev_b32 v62, 3, v0
    v_lshlrev_b32 v62, 10, v62
    v_and_b32 v1, 7, v0
    v_lshl_add_u32 v62, v1, 4, v62
    s_lshl_b32 s6, s5, 7
    v_add_u32 v63, s6, v62
    v_add_u32 v60, s94, v2
    v_lshrrev_b32 v61, 2, v0
    v_lshlrev_b32 v61, 7, v61
    v_and_b32 v1, 3, v0
    v_lshl_add_u32 v61, v1, 3, v61
    v_and_b32 v1, 48, v0
    v_lshlrev_b32 v1, 5, v1
    v_add3_u32 v61, v61, v1, s94
    s_mov_b32 s43, 0
    buffer_load_dwordx4 v[64:67], v63, s[44:47], s43 offen nt
    s_add_u32 s43, s43, 0x2000
    buffer_load_dwordx4 v[72:75], v63, s[44:47], s43 offen nt
    s_add_u32 s43, s43, 0x2000
    s_waitcnt vmcnt(1)
    buffer_load_dwordx4 v[80:83], v63, s[44:47], s43 offen nt
    s_add_u32 s43, s43, 0x2000
    ds_write_b128 v60, v[64:67] offset:23808
    s_waitcnt vmcnt(1)
    buffer_load_dwordx4 v[88:91], v63, s[44:47], s43 offen nt
    s_add_u32 s43, s43, 0x2000
    ds_write_b128 v60, v[72:75] offset:24832
    s_waitcnt vmcnt(1)
    buffer_load_dwordx4 v[68:71], v63, s[44:47], s43 offen nt
    s_add_u32 s43, s43, 0x2000
    ds_write_b128 v60, v[80:83] offset:25856
    s_waitcnt vmcnt(1)
    buffer_load_dwordx4 v[76:79], v63, s[44:47], s43 offen nt
    s_add_u32 s43, s43, 0x2000
    ds_write_b128 v60, v[88:91] offset:26880
    ds_read_b64_tr_b16 v[64:65], v61 offset:23808
    ds_read_b64_tr_b16 v[66:67], v61 offset:24320
    ds_read_b64_tr_b16 v[72:73], v61 offset:23840
    ds_read_b64_tr_b16 v[74:75], v61 offset:24352
    ds_read_b64_tr_b16 v[80:81], v61 offset:23872
    ds_read_b64_tr_b16 v[82:83], v61 offset:24384
    ds_read_b64_tr_b16 v[88:89], v61 offset:23904
    ds_read_b64_tr_b16 v[90:91], v61 offset:24416
    s_waitcnt vmcnt(1)
    buffer_load_dwordx4 v[84:87], v63, s[44:47], s43 offen nt
    s_add_u32 s43, s43, 0x2000
    ds_write_b128 v60, v[68:71] offset:23808
    s_waitcnt vmcnt(1)
    buffer_load_dwordx4 v[92:95], v63, s[44:47], s43 offen nt
    s_add_u32 s43, s43, 0x2000
    ds_write_b128 v60, v[76:79] offset:24832
    s_waitcnt vmcnt(1)
    buffer_load_dwordx4 v[96:99], v63, s[44:47], s43 offen nt
    s_add_u32 s43, s43, 0x2000
    ds_write_b128 v60, v[84:87] offset:25856
    s_waitcnt vmcnt(1)
    buffer_load_dwordx4 v[104:107], v63, s[44:47], s43 offen nt
    s_add_u32 s43, s43, 0x2000
    ds_write_b128 v60, v[92:95] offset:26880
    ds_read_b64_tr_b16 v[68:69], v61 offset:23808
    ds_read_b64_tr_b16 v[70:71], v61 offset:24320
    ds_read_b64_tr_b16 v[76:77], v61 offset:23840
    ds_read_b64_tr_b16 v[78:79], v61 offset:24352
    ds_read_b64_tr_b16 v[84:85], v61 offset:23872
    ds_read_b64_tr_b16 v[86:87], v61 offset:24384
    ds_read_b64_tr_b16 v[92:93], v61 offset:23904
    ds_read_b64_tr_b16 v[94:95], v61 offset:24416
    s_waitcnt vmcnt(1)
    buffer_load_dwordx4 v[112:115], v63, s[44:47], s43 offen nt
    s_add_u32 s43, s43, 0x2000
    ds_write_b128 v60, v[96:99] offset:23808
    s_waitcnt vmcnt(1)
    buffer_load_dwordx4 v[120:123], v63, s[44:47], s43 offen nt
    s_add_u32 s43, s43, 0x2000
    ds_write_b128 v60, v[104:107] offset:24832
    s_waitcnt vmcnt(1)
    buffer_load_dwordx4 v[100:103], v63, s[44:47], s43 offen nt
    s_add_u32 s43, s43, 0x2000
    ds_write_b128 v60, v[112:115] offset:25856
    s_waitcnt vmcnt(1)
    buffer_load_dwordx4 v[108:111], v63, s[44:47], s43 offen nt
    s_add_u32 s43, s43, 0x2000
    ds_write_b128 v60, v[120:123] offset:26880
    ds_read_b64_tr_b16 v[96:97], v61 offset:23808
    ds_read_b64_tr_b16 v[98:99], v61 offset:24320
    ds_read_b64_tr_b16 v[104:105], v61 offset:23840
    ds_read_b64_tr_b16 v[106:107], v61 offset:24352
    ds_read_b64_tr_b16 v[112:113], v61 offset:23872
    ds_read_b64_tr_b16 v[114:115], v61 offset:24384
    ds_read_b64_tr_b16 v[120:121], v61 offset:23904
    ds_read_b64_tr_b16 v[122:123], v61 offset:24416
    s_waitcnt vmcnt(1)
    buffer_load_dwordx4 v[116:119], v63, s[44:47], s43 offen nt
    s_add_u32 s43, s43, 0x2000
    ds_write_b128 v60, v[100:103] offset:23808
    s_waitcnt vmcnt(1)
    buffer_load_dwordx4 v[124:127], v63, s[44:47], s43 offen nt
    s_add_u32 s43, s43, 0x2000
    ds_write_b128 v60, v[108:111] offset:24832
    s_waitcnt vmcnt(1)
    ds_write_b128 v60, v[116:119] offset:25856
    s_waitcnt vmcnt(0)
    ds_write_b128 v60, v[124:127] offset:26880
    ds_read_b64_tr_b16 v[100:101], v61 offset:23808
    ds_read_b64_tr_b16 v[102:103], v61 offset:24320
    ds_read_b64_tr_b16 v[108:109], v61 offset:23840
    ds_read_b64_tr_b16 v[110:111], v61 offset:24352
    ds_read_b64_tr_b16 v[116:117], v61 offset:23872
    ds_read_b64_tr_b16 v[118:119], v61 offset:24384
    ds_read_b64_tr_b16 v[124:125], v61 offset:23904
    ds_read_b64_tr_b16 v[126:127], v61 offset:24416
    s_setpc_b64 s[90:91]
L_em0:
    s_sleep 3
L_em:
    ds_read_b32 v31, v30
    s_memrealtime s[22:23]
    s_waitcnt lgkmcnt(0)
    v_readfirstlane_b32 s7, v31
    s_mov_b32 s51, s22
    s_bfe_u32 s50, s7, 0x80010
    s_and_b32 s7, s7, 0xffff
    s_sub_u32 s50, s50, s7
    s_lshl_b32 s6, s22, 12
    s_sub_u32 s6, s6, s59
    s_ashr_i32 s6, s6, 8
    s_sub_u32 s7, s7, s56
    s_mul_i32 s23, s7, s49
    s_sub_u32 s6, s6, s23
    s_sub_u32 s6, s6, s52
    s_add_u32 s50, s50, 20
    s_mul_i32 s50, s50, 232
    s_sub_u32 s6, s6, s50
    s_sub_u32 s6, s6, s58
    s_ashr_i32 s6, s6, s57
    s_add_u32 s58, s58, s6
    s_mov_b32 s57, 2
    s_mul_i32 s23, s7, 66
    s_add_u32 s23, s23, 0x679
    s_mul_i32 s6, s58, s23
    s_ashr_i32 s6, s6, 20
    s_add_u32 s6, s6, 4
    s_max_i32 s6, s6, 0
    s_min_i32 s6, s6, 7
    s_lshl_b32 s6, s6, 3
    s_lshr_b64 s[22:23], s[24:25], s6
    v_mov_b32 v10, s22
    ds_write_b8 v30, v10 offset:3
    s_cmp_lt_u32 s7, s53
    s_cbranch_scc1 L_em0
    s_setpc_b64 s[90:91]
L_auxsync:
    v_mov_b32 v30, 21516
    v_mov_b32 v31, 1
    s_mov_b64 exec, 1
    ds_add_u32 v30, v31
    s_mov_b64 exec, -1
L_auxwait:
    ds_read_b32 v31, v30
    s_waitcnt lgkmcnt(0)
    v_readfirstlane_b32 s6, v31
    s_nop 0
    s_cmp_ge_u32 s6, s43
    s_cbranch_scc1 L_auxsync_done
    s_sleep 1
    s_branch L_auxwait
L_auxsync_done:
    s_setpc_b64 s[90:91]
L_epi:
    v_mov_b32 v18, v16
    v_mov_b32 v19, v16
    v_readfirstlane_b32 s88, v39
    v_mov_b32 v23, s58
    v_permlane32_swap_b32 v18, v19
    v_max_f32 v18, v18, v19
    v_mov_b32 v19, v18
    v_and_b32 v3, 31, v0
    v_lshlrev_b32 v3, 3, v3
    v_lshrrev_b32 v1, 5, v0
    v_lshl_add_u32 v3, v1, 2, v3
    v_permlane16_swap_b32 v18, v19
    v_max_f32 v18, v18, v19
    v_sub_f32 v19, v16, v18
    v_mul_f32 v19, s54, v19
    v_exp_f32 v19, v19
    v_mul_f32 v20, s54, v18
    v_add_u32 v3, s56, v3
    v_mul_f32 v21, v17, v19
    v_mul_f32 v22, v17, v19
    v_mov_b32 v18, v19
    s_nop 0
    v_permlane32_swap_b32 v21, v22
    v_permlane32_swap_b32 v19, v18
    v_add_f32 v21, v21, v22
    v_mov_b32 v22, v21
    s_nop 1
    v_permlane16_swap_b32 v21, v22
    v_add_f32 v21, v21, v22
    ds_write_b64 v23, v[20:21]
    s_lshr_b32 s6, s2, 6
    s_lshl_b32 s57, s6, 18
    s_add_u32 s57, s57, 0x100000
    s_mov_b32 s59, 0
    s_mov_b32 s51, 1
    s_mov_b32 s53, 0x20000
    s_mov_b32 s93, 0
    s_cmp_lg_u32 s5, 1
    s_cbranch_scc1 L_ra
    s_lshl_b32 s57, s6, 17
    s_add_u32 s57, s57, 0x80000
    s_mov_b32 s59, 1024
    s_mov_b32 s51, 2
    s_mov_b32 s53, 0x10000
L_ra:
    s_setpc_b64 s[90:91]
L_reduce:
    s_and_b32 s7, s2, 63
    s_bfe_u32 s43, s2, 0x30001
    s_lshl_b32 s43, s43, 3
    s_bfe_u32 s7, s2, 0x20004
    s_lshl_b32 s7, s7, 1
    s_or_b32 s7, s7, s43
    s_and_b32 s43, s2, 1
    s_or_b32 s7, s7, s43
    s_lshl_b32 s43, s7, 5
    s_add_u32 s57, s57, s43
    s_and_b32 s43, s43, 1792
    s_add_u32 s57, s57, s43
    v_lshrrev_b32 v24, s51, v0
    v_lshlrev_b32 v24, 12, v24
    v_and_b32 v26, 1, v0
    v_lshl_add_u32 v24, v26, 4, v24
    v_add_u32 v24, s57, v24
    v_add_u32 v25, s53, v24
    s_lshr_b32 s6, s2, 6
    s_lshl_b32 s6, s6, 11
    s_add_u32 s59, s59, s6
    s_lshr_b32 s6, s7, 3
    s_lshl_b32 s6, s6, 7
    s_add_u32 s59, s59, s6
    s_and_b32 s6, s7, 7
    s_lshl_b32 s6, s6, 2
    s_add_u32 s59, s59, s6
    v_and_b32 v27, 16, v0
    v_lshlrev_b32 v27, 2, v27
    v_and_b32 v28, 32, v0
    v_add3_u32 v27, v27, v28, s59
    v_lshl_add_u32 v27, v26, 1, v27
    s_mov_b32 s6, 0x00030003
    s_mov_b32 s7, 0x00030003
    s_mov_b32 s42, 0x100000
    s_cmp_lg_u32 s93, 0
    s_cbranch_scc1 L_red_go
    s_barrier
L_red_poll:
L_red_p1:
    global_load_dwordx4 v[8:11], v24, s[40:41] sc1
    global_load_dwordx4 v[12:15], v25, s[40:41] sc1
L_red_p2:
    s_sub_u32 s42, s42, 1
    s_cselect_b64 s[22:23], 0, -1
    s_waitcnt vmcnt(1)
    v_cmp_ne_u32 vcc, s88, v10
    s_waitcnt vmcnt(0)
    v_cmp_ne_u32 s[24:25], s88, v14
    s_nop 0
    s_or_b64 vcc, vcc, s[24:25]
    s_and_b64 exec, vcc, s[22:23]
    s_cbranch_scc1 L_red_poll
L_red_go:
    s_mov_b64 exec, -1
    v_sub_f32_dpp v10, v11, v11 quad_perm:[2,3,0,1] row_mask:0xf bank_mask:0xf
    v_sub_f32_dpp v14, v15, v15 quad_perm:[2,3,0,1] row_mask:0xf bank_mask:0xf
    v_exp_f32 v10, v10
    v_exp_f32 v14, v14
    v_lshlrev_b32 v20, 16, v8
    v_lshlrev_b32 v21, 16, v9
    v_add_f32 v10, 1.0, v10
    v_add_f32 v14, 1.0, v14
    v_rcp_f32 v10, v10
    v_rcp_f32 v14, v14
    v_lshlrev_b32 v22, 16, v12
    v_lshlrev_b32 v23, 16, v13
    v_mul_f32 v16, v10, v20
    v_mul_f32 v18, v10, v21
    v_fmac_f32 v16, v14, v22
    v_fmac_f32 v18, v14, v23
    v_and_b32 v8, 0xffff0000, v8
    v_and_b32 v9, 0xffff0000, v9
    v_and_b32 v12, 0xffff0000, v12
    v_and_b32 v13, 0xffff0000, v13
    v_permlane32_swap_b32 v16, v18
    v_mul_f32 v17, v10, v8
    v_mul_f32 v19, v10, v9
    v_fmac_f32 v17, v14, v12
    v_fmac_f32 v19, v14, v13
    v_add_f32 v16, v16, v18
    s_nop 0
    v_permlane32_swap_b32 v17, v19
    v_add_f32 v17, v17, v19
    s_nop 1
    v_permlane16_swap_b32 v16, v17
    v_add_f32 v16, v16, v17
    s_nop 1
    v_add_f32_dpp v16, v16, v16 row_ror:8 row_mask:0xf bank_mask:0xf
    s_cmp_lg_u32 s93, 0
    s_nop 0
    v_add_f32_dpp v16, v16, v16 row_ror:4 row_mask:0xf bank_mask:0xf
    s_cbranch_scc1 L_red_ret
    s_nop 0
    v_add_f32_dpp v16, v16, v16 quad_perm:[2,3,0,1] row_mask:0xf bank_mask:0xf
    s_mov_b64 exec, s[6:7]
    v_cvt_pk_bf16_f32 v16, v16, v16
    global_store_short v27, v16, s[36:37]
    s_mov_b64 exec, -1
L_red_ret:
    s_setpc_b64 s[90:91]
.section .rodata,"a"
.p2align 6
.amdhsa_kernel concat_heads__mha_block_cached__sliding_block_cached__decode_kernel
  .amdhsa_next_free_vgpr 128
  .amdhsa_next_free_sgpr 96
  .amdhsa_accum_offset 128
  .amdhsa_group_segment_fixed_size 0
  .amdhsa_kernarg_size 104
  .amdhsa_user_sgpr_count 2
  .amdhsa_user_sgpr_kernarg_segment_ptr 1
  .amdhsa_system_sgpr_workgroup_id_x 1
.end_amdhsa_kernel
```
